```python
import torch

def _softmax(x, axis=-1):
    return torch.softmax(x, dim=axis)
def _gelu(x):
    return torch.nn.functional.gelu(x, approximate="tanh")
def _silu(x):
    return torch.nn.functional.silu(x)
def _sigmoid(x):
    return torch.sigmoid(x)
def _layernorm(x, axis=-1, eps=1e-5):
    m = x.mean(dim=axis, keepdim=True)
    v = x.var(dim=axis, keepdim=True, unbiased=False)
    return (x - m) / torch.sqrt(v + eps)
def _scatter_add(tgt, idx, src, axis=0):
    return tgt.clone().index_add_(axis, idx, src)
def _segment_sum(src, seg, n):
    out = torch.zeros((n,) + src.shape[1:], dtype=src.dtype)
    return out.index_add_(0, seg, src)
def _pad(x, pw):
    flat = tuple(v for pair in reversed(pw) for v in pair)
    return torch.nn.functional.pad(x, flat)

kernel_name = 'concat_heads__ssm_conv_s5__mha_block__prompt'

def setup_inputs():

    _w = (lambda a: (lambda t: t.to(torch.bfloat16) if t.is_floating_point() else t)(torch.as_tensor(a)))
    def _A_setup():
        B, S, D = 1, 2048, 576
        P = D
        Lambda_re = -0.5 * (lambda _x: torch.exp(torch.as_tensor(_x)))((lambda *s: torch.randn(*s, dtype=torch.bfloat16) * 0.4)(P))
        Lambda_im = (lambda *s: torch.randn(*s, dtype=torch.bfloat16) * 0.8)(P) * 1.0
        B_re = (lambda *s: torch.randn(*s, dtype=torch.bfloat16) * 0.8)(P, D) * (D ** -0.5)
        B_im = (lambda *s: torch.randn(*s, dtype=torch.bfloat16) * 0.8)(P, D) * (D ** -0.5)
        C_re = (lambda *s: torch.randn(*s, dtype=torch.bfloat16) * 0.8)(D, P) * (P ** -0.5)
        C_im = (lambda *s: torch.randn(*s, dtype=torch.bfloat16) * 0.8)(D, P) * (P ** -0.5)
        log_dt = (lambda *s: torch.randn(*s, dtype=torch.bfloat16) * 0.4)(P) * 0.3 - 2.0
        Dskip = (lambda *s: torch.randn(*s, dtype=torch.bfloat16) * 0.1)(D)
        return {
            "x": _w((lambda *s: torch.randn(*s, dtype=torch.bfloat16) * 0.05)(B, S, D)),
            "Lambda_re": _w(Lambda_re),
            "Lambda_im": _w(Lambda_im),
            "B_re": _w(B_re),
            "B_im": _w(B_im),
            "C_re": _w(C_re),
            "C_im": _w(C_im),
            "log_dt": _w(log_dt),
            "Dskip": _w(Dskip),
        }
    _A_in = _A_setup()

    def _B_setup():
        B, S, D, H = 1, 2048, 576, 32
        return {
            "x": _w((lambda *s: torch.randn(*s, dtype=torch.bfloat16) * 0.2)(B, S, D)),
            "wqkv": _w((lambda *s: torch.randn(*s, dtype=torch.bfloat16) * 0.2)(D, 3 * D)),
            "wo": _w((lambda *s: torch.randn(*s, dtype=torch.bfloat16) * 0.05)(D, D)),
        }
    _B_in = _B_setup()

    return {
        "A_x": _A_in["x"],
        "A_Lambda_re": _A_in["Lambda_re"],
        "A_Lambda_im": _A_in["Lambda_im"],
        "A_B_re": _A_in["B_re"],
        "A_B_im": _A_in["B_im"],
        "A_C_re": _A_in["C_re"],
        "A_C_im": _A_in["C_im"],
        "A_log_dt": _A_in["log_dt"],
        "A_Dskip": _A_in["Dskip"],
        "B_x": _B_in["x"],
        "B_wqkv": _B_in["wqkv"],
        "B_wo": _B_in["wo"],
    }

def reference(A_x, A_Lambda_re, A_Lambda_im, A_B_re, A_B_im, A_C_re, A_C_im, A_log_dt, A_Dskip, B_x, B_wqkv, B_wo):
    def _A_ref(x, Lambda_re, Lambda_im, B_re, B_im, C_re, C_im, log_dt, Dskip):
        Bsz, L, H = x.shape
        Lam = Lambda_re + 1j * Lambda_im
        Bmat = B_re + 1j * B_im
        Cmat = C_re + 1j * C_im
        dt = torch.exp(log_dt)
        Lam_bar = torch.exp(dt * Lam)
        B_bar = ((Lam_bar - 1.0) / Lam)[:, None] * Bmat
        Bu = torch.einsum("bld,pd->blp", x + 0j, B_bar)
        h = torch.zeros_like(Bu[:, 0, :])
        hs = []
        for t in range(L):
            h = Lam_bar[None, :] * h + Bu[:, t, :]
            hs.append(h)
        hseq = torch.stack(hs, 1)
        y = 2.0 * torch.einsum("blp,dp->bld", hseq, Cmat).real + x * Dskip[None, None, :]
        return y

    def _B_ref(x, wqkv, wo):
        B, S, D = x.shape
        H = 32
        Dh = D // H
        qkv = (lambda x, *d: x.permute(*d))((x @ wqkv).reshape(B, S, 3, H, Dh), 2, 0, 3, 1, 4)
        q, k, v = qkv[0], qkv[1], qkv[2]
        scores = torch.einsum("bhqd,bhkd->bhqk", q, k) * (Dh ** -0.5)
        p = _softmax(scores, axis=-1)
        o = torch.einsum("bhqk,bhkd->bhqd", p, v)
        return (lambda x, *d: x.permute(*d))(o, 0, 2, 1, 3).reshape(B, S, D) @ wo

    a = _A_ref(A_x, A_Lambda_re, A_Lambda_im, A_B_re, A_B_im, A_C_re, A_C_im, A_log_dt, A_Dskip)
    b = _B_ref(B_x, B_wqkv, B_wo)
    return torch.concatenate([a, b], axis=-1)
```

```asm
; @launch kernel=s5mha_k1_kernel grid=(256,1,1) block=(512,1,1) lds=163840
; @launch kernel=s5mha_k2_kernel grid=(256,1,1) block=(1024,1,1) lds=160832
; @launch kernel=s5mha_k3_kernel grid=(256,1,1) block=(640,1,1) lds=163840
.amdgcn_target "amdgcn-amd-amdhsa--gfx950"
.text
.globl s5mha_k1_kernel
.p2align 8
.type s5mha_k1_kernel,@function
s5mha_k1_kernel:

    s_cmp_ge_u32 s2, 256
    s_cbranch_scc1 L_k1_end
    s_load_dwordx2 s[40:41], s[0:1], 112
    s_load_dwordx2 s[42:43], s[0:1], 0
    s_load_dwordx2 s[44:45], s[0:1], 72
    s_load_dwordx4 s[48:51], s[0:1], 24
    s_load_dwordx2 s[52:53], s[0:1], 80
    v_lshrrev_b32 v1, 6, v0
    v_and_b32 v2, 63, v0
    s_and_b32 s7, s2, 7
    v_readfirstlane_b32 s3, v1
    s_lshr_b32 s35, s2, 3
    s_mov_b32 s4, 1
    s_cmp_ge_u32 s7, 3
    s_cselect_b32 s4, 0, s4
    s_and_b32 s36, s35, 7
    s_lshr_b32 s37, s35, 3
    s_cmp_eq_u32 s7, 2
    s_cbranch_scc1 L_k1_d2
    s_cmp_eq_u32 s7, 7
    s_cbranch_scc1 L_k1_d7
    s_cmp_ge_u32 s7, 5
    s_cselect_b32 s38, 4, 0
    s_add_u32 s6, s37, s38
    s_cmp_ge_u32 s7, 3
    s_cselect_b32 s38, 1, 0
    s_add_u32 s38, s38, s7
    s_and_b32 s38, s38, 1
    s_lshl_b32 s38, s38, 3
    s_add_u32 s5, s36, s38
    s_branch L_k1_dd
L_k1_d2:
    s_and_b32 s5, s35, 15
    s_lshr_b32 s6, s35, 4
    s_add_u32 s6, s6, 4
    s_branch L_k1_dd
L_k1_d7:
    s_mov_b32 s5, s35
    s_mov_b32 s6, 8
    s_cmp_ge_u32 s35, 16
    s_cbranch_scc1 L_k1_prep
L_k1_dd:
    s_cmp_lg_u32 s3, 3
    s_cbranch_scc1 L_k1_nocpf
    s_getpc_b64 s[76:77]
L_cpf_k1:
    s_add_u32 s76, s76, s5mha_k1_kernel-L_cpf_k1
    s_addc_u32 s77, s77, ((s5mha_k1_kernel-L_cpf_k1)>>32)
    v_lshlrev_b32 v62, 7, v2
    v_min_u32 v62, L_k1_codeend-s5mha_k1_kernel-4, v62
    global_load_dword v63, v62, s[76:77]
    v_lshlrev_b32 v62, 7, v2
    v_add_u32 v62, 8192, v62
    v_min_u32 v62, L_k1_codeend-s5mha_k1_kernel-4, v62
    global_load_dword v63, v62, s[76:77]
L_k1_nocpf:
    s_cmp_lt_u32 s3, 4
    s_cbranch_scc1 L_k1_cons
L_k1_prod:
    s_sub_u32 s36, s3, 4
    v_lshrrev_b32 v3, 3, v2
    s_lshl_b32 s37, s36, 3
    v_add_u32 v3, s37, v3
    v_and_b32 v4, 7, v2
    v_bfe_u32 v5, v3, 1, 3
    v_xor_b32 v4, v4, v5
    v_lshlrev_b32 v4, 4, v4
    v_mul_u32_u24 v5, 1152, v3
    v_add_u32 v8, v5, v4
    s_mul_i32 s54, s5, 147456
    s_lshl_b32 s55, s36, 10
    s_mov_b32 s47, 0
    s_cmp_eq_u32 s4, 1
    s_cbranch_scc1 L_k1_pbu
    v_cmp_lt_u32 vcc, 23, v2
    v_mov_b32 v5, 0
    v_mov_b32 v6, 3456
    v_cndmask_b32 v5, v5, v6, vcc
    v_mov_b32 v6, 24
    v_cndmask_b32 v6, 0, v6, vcc
    v_sub_u32 v6, v2, v6
    s_and_b32 s37, s36, 1
    s_lshl_b32 s37, s37, 2
    v_xor_b32 v6, s37, v6
    v_lshl_add_u32 v9, v6, 4, v5
    s_mov_b32 s74, -1
    s_mov_b32 s75, 0xffff
    s_mul_i32 s59, s6, 384
    s_mul_i32 s38, s36, 6912
    s_add_u32 s59, s59, s38
    s_mul_i32 s46, s36, 768
    s_add_u32 s46, s46, 16384
    s_waitcnt lgkmcnt(0)
    s_mov_b32 s8, s44
    s_and_b32 s9, s45, 0xffff
    s_mov_b32 s10, 2359296
    s_mov_b32 s11, 0x20000
    s_mov_b32 s12, s52
    s_and_b32 s13, s53, 0xffff
    s_mov_b32 s14, 1990656
    s_mov_b32 s15, 0x20000
    s_add_u32 s56, s55, s47
    s_add_u32 m0, s56, 0
    s_add_u32 s57, s54, 0
    buffer_load_dwordx4 v8, s[8:11], s57 offen lds
    s_add_u32 s56, s55, s47
    s_add_u32 m0, s56, 4096
    s_add_u32 s57, s54, 36864
    buffer_load_dwordx4 v8, s[8:11], s57 offen lds
    s_add_u32 s56, s55, s47
    s_add_u32 m0, s56, 8192
    s_add_u32 s57, s54, 73728
    buffer_load_dwordx4 v8, s[8:11], s57 offen lds
    s_add_u32 s56, s55, s47
    s_add_u32 m0, s56, 12288
    s_add_u32 s57, s54, 110592
    buffer_load_dwordx4 v8, s[8:11], s57 offen lds
    s_mov_b64 exec, s[74:75]
    s_add_u32 s56, s46, s47
    s_add_u32 m0, s56, 0
    s_add_u32 s57, s59, 0
    buffer_load_dwordx4 v9, s[12:15], s57 offen lds
    s_add_u32 s56, s46, s47
    s_add_u32 m0, s56, 3072
    s_add_u32 s57, s59, 27648
    buffer_load_dwordx4 v9, s[12:15], s57 offen lds
    s_add_u32 s56, s46, s47
    s_add_u32 m0, s56, 6144
    s_add_u32 s57, s59, 55296
    buffer_load_dwordx4 v9, s[12:15], s57 offen lds
    s_add_u32 s56, s46, s47
    s_add_u32 m0, s56, 9216
    s_add_u32 s57, s59, 82944
    buffer_load_dwordx4 v9, s[12:15], s57 offen lds
    s_add_u32 s56, s46, s47
    s_add_u32 m0, s56, 12288
    s_add_u32 s57, s59, 110592
    buffer_load_dwordx4 v9, s[12:15], s57 offen lds
    s_add_u32 s56, s46, s47
    s_add_u32 m0, s56, 15360
    s_add_u32 s57, s59, 138240
    buffer_load_dwordx4 v9, s[12:15], s57 offen lds
    s_add_u32 s56, s46, s47
    s_add_u32 m0, s56, 18432
    s_add_u32 s57, s59, 165888
    buffer_load_dwordx4 v9, s[12:15], s57 offen lds
    s_add_u32 s56, s46, s47
    s_add_u32 m0, s56, 21504
    s_add_u32 s57, s59, 193536
    buffer_load_dwordx4 v9, s[12:15], s57 offen lds
    s_mov_b64 exec, -1
    s_add_u32 s59, s59, 221184
    s_add_u32 s54, s54, 128
    s_add_u32 s47, s47, 40960
    s_cmp_eq_u32 s47, 163840
    s_cselect_b32 s47, 0, s47
    s_add_u32 s56, s55, s47
    s_add_u32 m0, s56, 0
    s_add_u32 s57, s54, 0
    buffer_load_dwordx4 v8, s[8:11], s57 offen lds
    s_add_u32 s56, s55, s47
    s_add_u32 m0, s56, 4096
    s_add_u32 s57, s54, 36864
    buffer_load_dwordx4 v8, s[8:11], s57 offen lds
    s_add_u32 s56, s55, s47
    s_add_u32 m0, s56, 8192
    s_add_u32 s57, s54, 73728
    buffer_load_dwordx4 v8, s[8:11], s57 offen lds
    s_add_u32 s56, s55, s47
    s_add_u32 m0, s56, 12288
    s_add_u32 s57, s54, 110592
    buffer_load_dwordx4 v8, s[8:11], s57 offen lds
    s_mov_b64 exec, s[74:75]
    s_add_u32 s56, s46, s47
    s_add_u32 m0, s56, 0
    s_add_u32 s57, s59, 0
    buffer_load_dwordx4 v9, s[12:15], s57 offen lds
    s_add_u32 s56, s46, s47
    s_add_u32 m0, s56, 3072
    s_add_u32 s57, s59, 27648
    buffer_load_dwordx4 v9, s[12:15], s57 offen lds
    s_add_u32 s56, s46, s47
    s_add_u32 m0, s56, 6144
    s_add_u32 s57, s59, 55296
    buffer_load_dwordx4 v9, s[12:15], s57 offen lds
    s_add_u32 s56, s46, s47
    s_add_u32 m0, s56, 9216
    s_add_u32 s57, s59, 82944
    buffer_load_dwordx4 v9, s[12:15], s57 offen lds
    s_add_u32 s56, s46, s47
    s_add_u32 m0, s56, 12288
    s_add_u32 s57, s59, 110592
    buffer_load_dwordx4 v9, s[12:15], s57 offen lds
    s_add_u32 s56, s46, s47
    s_add_u32 m0, s56, 15360
    s_add_u32 s57, s59, 138240
    buffer_load_dwordx4 v9, s[12:15], s57 offen lds
    s_add_u32 s56, s46, s47
    s_add_u32 m0, s56, 18432
    s_add_u32 s57, s59, 165888
    buffer_load_dwordx4 v9, s[12:15], s57 offen lds
    s_add_u32 s56, s46, s47
    s_add_u32 m0, s56, 21504
    s_add_u32 s57, s59, 193536
    buffer_load_dwordx4 v9, s[12:15], s57 offen lds
    s_mov_b64 exec, -1
    s_add_u32 s59, s59, 221184
    s_add_u32 s54, s54, 128
    s_add_u32 s47, s47, 40960
    s_cmp_eq_u32 s47, 163840
    s_cselect_b32 s47, 0, s47
    s_waitcnt vmcnt(12)
    s_barrier
    s_add_u32 s56, s55, s47
    s_add_u32 m0, s56, 0
    s_add_u32 s57, s54, 0
    buffer_load_dwordx4 v8, s[8:11], s57 offen lds
    s_add_u32 s56, s55, s47
    s_add_u32 m0, s56, 4096
    s_add_u32 s57, s54, 36864
    buffer_load_dwordx4 v8, s[8:11], s57 offen lds
    s_add_u32 s56, s55, s47
    s_add_u32 m0, s56, 8192
    s_add_u32 s57, s54, 73728
    buffer_load_dwordx4 v8, s[8:11], s57 offen lds
    s_add_u32 s56, s55, s47
    s_add_u32 m0, s56, 12288
    s_add_u32 s57, s54, 110592
    buffer_load_dwordx4 v8, s[8:11], s57 offen lds
    s_mov_b64 exec, s[74:75]
    s_add_u32 s56, s46, s47
    s_add_u32 m0, s56, 0
    s_add_u32 s57, s59, 0
    buffer_load_dwordx4 v9, s[12:15], s57 offen lds
    s_add_u32 s56, s46, s47
    s_add_u32 m0, s56, 3072
    s_add_u32 s57, s59, 27648
    buffer_load_dwordx4 v9, s[12:15], s57 offen lds
    s_add_u32 s56, s46, s47
    s_add_u32 m0, s56, 6144
    s_add_u32 s57, s59, 55296
    buffer_load_dwordx4 v9, s[12:15], s57 offen lds
    s_add_u32 s56, s46, s47
    s_add_u32 m0, s56, 9216
    s_add_u32 s57, s59, 82944
    buffer_load_dwordx4 v9, s[12:15], s57 offen lds
    s_add_u32 s56, s46, s47
    s_add_u32 m0, s56, 12288
    s_add_u32 s57, s59, 110592
    buffer_load_dwordx4 v9, s[12:15], s57 offen lds
    s_add_u32 s56, s46, s47
    s_add_u32 m0, s56, 15360
    s_add_u32 s57, s59, 138240
    buffer_load_dwordx4 v9, s[12:15], s57 offen lds
    s_add_u32 s56, s46, s47
    s_add_u32 m0, s56, 18432
    s_add_u32 s57, s59, 165888
    buffer_load_dwordx4 v9, s[12:15], s57 offen lds
    s_add_u32 s56, s46, s47
    s_add_u32 m0, s56, 21504
    s_add_u32 s57, s59, 193536
    buffer_load_dwordx4 v9, s[12:15], s57 offen lds
    s_mov_b64 exec, -1
    s_add_u32 s59, s59, 221184
    s_add_u32 s54, s54, 128
    s_add_u32 s47, s47, 40960
    s_cmp_eq_u32 s47, 163840
    s_cselect_b32 s47, 0, s47
    s_mov_b32 s58, 6
L_k1_qploop:
    s_waitcnt vmcnt(12)
    s_barrier
    s_add_u32 s56, s55, s47
    s_add_u32 m0, s56, 0
    s_add_u32 s57, s54, 0
    buffer_load_dwordx4 v8, s[8:11], s57 offen lds
    s_add_u32 s56, s55, s47
    s_add_u32 m0, s56, 4096
    s_add_u32 s57, s54, 36864
    buffer_load_dwordx4 v8, s[8:11], s57 offen lds
    s_add_u32 s56, s55, s47
    s_add_u32 m0, s56, 8192
    s_add_u32 s57, s54, 73728
    buffer_load_dwordx4 v8, s[8:11], s57 offen lds
    s_add_u32 s56, s55, s47
    s_add_u32 m0, s56, 12288
    s_add_u32 s57, s54, 110592
    buffer_load_dwordx4 v8, s[8:11], s57 offen lds
    s_mov_b64 exec, s[74:75]
    s_add_u32 s56, s46, s47
    s_add_u32 m0, s56, 0
    s_add_u32 s57, s59, 0
    buffer_load_dwordx4 v9, s[12:15], s57 offen lds
    s_add_u32 s56, s46, s47
    s_add_u32 m0, s56, 3072
    s_add_u32 s57, s59, 27648
    buffer_load_dwordx4 v9, s[12:15], s57 offen lds
    s_add_u32 s56, s46, s47
    s_add_u32 m0, s56, 6144
    s_add_u32 s57, s59, 55296
    buffer_load_dwordx4 v9, s[12:15], s57 offen lds
    s_add_u32 s56, s46, s47
    s_add_u32 m0, s56, 9216
    s_add_u32 s57, s59, 82944
    buffer_load_dwordx4 v9, s[12:15], s57 offen lds
    s_add_u32 s56, s46, s47
    s_add_u32 m0, s56, 12288
    s_add_u32 s57, s59, 110592
    buffer_load_dwordx4 v9, s[12:15], s57 offen lds
    s_add_u32 s56, s46, s47
    s_add_u32 m0, s56, 15360
    s_add_u32 s57, s59, 138240
    buffer_load_dwordx4 v9, s[12:15], s57 offen lds
    s_add_u32 s56, s46, s47
    s_add_u32 m0, s56, 18432
    s_add_u32 s57, s59, 165888
    buffer_load_dwordx4 v9, s[12:15], s57 offen lds
    s_add_u32 s56, s46, s47
    s_add_u32 m0, s56, 21504
    s_add_u32 s57, s59, 193536
    buffer_load_dwordx4 v9, s[12:15], s57 offen lds
    s_mov_b64 exec, -1
    s_add_u32 s59, s59, 221184
    s_add_u32 s54, s54, 128
    s_add_u32 s47, s47, 40960
    s_cmp_eq_u32 s47, 163840
    s_cselect_b32 s47, 0, s47
    s_sub_u32 s58, s58, 1
    s_cmp_lg_u32 s58, 0
    s_cbranch_scc1 L_k1_qploop
    s_waitcnt vmcnt(12)
    s_barrier
    s_waitcnt vmcnt(0)
    s_barrier
    s_endpgm
L_k1_pbu:
    s_mul_i32 s38, s6, 96
    v_add_u32 v5, s38, v3
    v_mul_u32_u24 v5, 1152, v5
    v_add_u32 v9, v5, v4
    s_mov_b32 s59, 0
    s_add_u32 s46, s55, 16384
    s_waitcnt lgkmcnt(0)
    s_mov_b32 s8, s42
    s_and_b32 s9, s43, 0xffff
    s_mov_b32 s10, 2359296
    s_mov_b32 s11, 0x20000
    s_mov_b32 s12, s48
    s_and_b32 s13, s49, 0xffff
    s_mov_b32 s14, 663552
    s_mov_b32 s15, 0x20000
    s_mov_b32 s16, s50
    s_and_b32 s17, s51, 0xffff
    s_mov_b32 s18, 663552
    s_mov_b32 s19, 0x20000
    s_add_u32 s56, s55, s47
    s_add_u32 m0, s56, 0
    s_add_u32 s57, s54, 0
    buffer_load_dwordx4 v8, s[8:11], s57 offen lds
    s_add_u32 s56, s55, s47
    s_add_u32 m0, s56, 4096
    s_add_u32 s57, s54, 36864
    buffer_load_dwordx4 v8, s[8:11], s57 offen lds
    s_add_u32 s56, s55, s47
    s_add_u32 m0, s56, 8192
    s_add_u32 s57, s54, 73728
    buffer_load_dwordx4 v8, s[8:11], s57 offen lds
    s_add_u32 s56, s55, s47
    s_add_u32 m0, s56, 12288
    s_add_u32 s57, s54, 110592
    buffer_load_dwordx4 v8, s[8:11], s57 offen lds
    s_add_u32 s56, s46, s47
    s_add_u32 m0, s56, 0
    s_add_u32 s57, s59, 0
    buffer_load_dwordx4 v9, s[12:15], s57 offen lds
    s_add_u32 s56, s46, s47
    s_add_u32 m0, s56, 4096
    s_add_u32 s57, s59, 36864
    buffer_load_dwordx4 v9, s[12:15], s57 offen lds
    s_add_u32 s56, s46, s47
    s_add_u32 m0, s56, 8192
    s_add_u32 s57, s59, 73728
    buffer_load_dwordx4 v9, s[12:15], s57 offen lds
    s_add_u32 s56, s46, s47
    s_add_u32 m0, s56, 12288
    s_add_u32 s57, s59, 0
    buffer_load_dwordx4 v9, s[16:19], s57 offen lds
    s_add_u32 s56, s46, s47
    s_add_u32 m0, s56, 16384
    s_add_u32 s57, s59, 36864
    buffer_load_dwordx4 v9, s[16:19], s57 offen lds
    s_add_u32 s56, s46, s47
    s_add_u32 m0, s56, 20480
    s_add_u32 s57, s59, 73728
    buffer_load_dwordx4 v9, s[16:19], s57 offen lds
    s_add_u32 s59, s59, 128
    s_add_u32 s54, s54, 128
    s_add_u32 s47, s47, 40960
    s_cmp_eq_u32 s47, 163840
    s_cselect_b32 s47, 0, s47
    s_add_u32 s56, s55, s47
    s_add_u32 m0, s56, 0
    s_add_u32 s57, s54, 0
    buffer_load_dwordx4 v8, s[8:11], s57 offen lds
    s_add_u32 s56, s55, s47
    s_add_u32 m0, s56, 4096
    s_add_u32 s57, s54, 36864
    buffer_load_dwordx4 v8, s[8:11], s57 offen lds
    s_add_u32 s56, s55, s47
    s_add_u32 m0, s56, 8192
    s_add_u32 s57, s54, 73728
    buffer_load_dwordx4 v8, s[8:11], s57 offen lds
    s_add_u32 s56, s55, s47
    s_add_u32 m0, s56, 12288
    s_add_u32 s57, s54, 110592
    buffer_load_dwordx4 v8, s[8:11], s57 offen lds
    s_add_u32 s56, s46, s47
    s_add_u32 m0, s56, 0
    s_add_u32 s57, s59, 0
    buffer_load_dwordx4 v9, s[12:15], s57 offen lds
    s_add_u32 s56, s46, s47
    s_add_u32 m0, s56, 4096
    s_add_u32 s57, s59, 36864
    buffer_load_dwordx4 v9, s[12:15], s57 offen lds
    s_add_u32 s56, s46, s47
    s_add_u32 m0, s56, 8192
    s_add_u32 s57, s59, 73728
    buffer_load_dwordx4 v9, s[12:15], s57 offen lds
    s_add_u32 s56, s46, s47
    s_add_u32 m0, s56, 12288
    s_add_u32 s57, s59, 0
    buffer_load_dwordx4 v9, s[16:19], s57 offen lds
    s_add_u32 s56, s46, s47
    s_add_u32 m0, s56, 16384
    s_add_u32 s57, s59, 36864
    buffer_load_dwordx4 v9, s[16:19], s57 offen lds
    s_add_u32 s56, s46, s47
    s_add_u32 m0, s56, 20480
    s_add_u32 s57, s59, 73728
    buffer_load_dwordx4 v9, s[16:19], s57 offen lds
    s_add_u32 s59, s59, 128
    s_add_u32 s54, s54, 128
    s_add_u32 s47, s47, 40960
    s_cmp_eq_u32 s47, 163840
    s_cselect_b32 s47, 0, s47
    s_waitcnt vmcnt(10)
    s_barrier
    s_add_u32 s56, s55, s47
    s_add_u32 m0, s56, 0
    s_add_u32 s57, s54, 0
    buffer_load_dwordx4 v8, s[8:11], s57 offen lds
    s_add_u32 s56, s55, s47
    s_add_u32 m0, s56, 4096
    s_add_u32 s57, s54, 36864
    buffer_load_dwordx4 v8, s[8:11], s57 offen lds
    s_add_u32 s56, s55, s47
    s_add_u32 m0, s56, 8192
    s_add_u32 s57, s54, 73728
    buffer_load_dwordx4 v8, s[8:11], s57 offen lds
    s_add_u32 s56, s55, s47
    s_add_u32 m0, s56, 12288
    s_add_u32 s57, s54, 110592
    buffer_load_dwordx4 v8, s[8:11], s57 offen lds
    s_add_u32 s56, s46, s47
    s_add_u32 m0, s56, 0
    s_add_u32 s57, s59, 0
    buffer_load_dwordx4 v9, s[12:15], s57 offen lds
    s_add_u32 s56, s46, s47
    s_add_u32 m0, s56, 4096
    s_add_u32 s57, s59, 36864
    buffer_load_dwordx4 v9, s[12:15], s57 offen lds
    s_add_u32 s56, s46, s47
    s_add_u32 m0, s56, 8192
    s_add_u32 s57, s59, 73728
    buffer_load_dwordx4 v9, s[12:15], s57 offen lds
    s_add_u32 s56, s46, s47
    s_add_u32 m0, s56, 12288
    s_add_u32 s57, s59, 0
    buffer_load_dwordx4 v9, s[16:19], s57 offen lds
    s_add_u32 s56, s46, s47
    s_add_u32 m0, s56, 16384
    s_add_u32 s57, s59, 36864
    buffer_load_dwordx4 v9, s[16:19], s57 offen lds
    s_add_u32 s56, s46, s47
    s_add_u32 m0, s56, 20480
    s_add_u32 s57, s59, 73728
    buffer_load_dwordx4 v9, s[16:19], s57 offen lds
    s_add_u32 s59, s59, 128
    s_add_u32 s54, s54, 128
    s_add_u32 s47, s47, 40960
    s_cmp_eq_u32 s47, 163840
    s_cselect_b32 s47, 0, s47
    s_mov_b32 s58, 6
L_k1_bploop:
    s_waitcnt vmcnt(10)
    s_barrier
    s_add_u32 s56, s55, s47
    s_add_u32 m0, s56, 0
    s_add_u32 s57, s54, 0
    buffer_load_dwordx4 v8, s[8:11], s57 offen lds
    s_add_u32 s56, s55, s47
    s_add_u32 m0, s56, 4096
    s_add_u32 s57, s54, 36864
    buffer_load_dwordx4 v8, s[8:11], s57 offen lds
    s_add_u32 s56, s55, s47
    s_add_u32 m0, s56, 8192
    s_add_u32 s57, s54, 73728
    buffer_load_dwordx4 v8, s[8:11], s57 offen lds
    s_add_u32 s56, s55, s47
    s_add_u32 m0, s56, 12288
    s_add_u32 s57, s54, 110592
    buffer_load_dwordx4 v8, s[8:11], s57 offen lds
    s_add_u32 s56, s46, s47
    s_add_u32 m0, s56, 0
    s_add_u32 s57, s59, 0
    buffer_load_dwordx4 v9, s[12:15], s57 offen lds
    s_add_u32 s56, s46, s47
    s_add_u32 m0, s56, 4096
    s_add_u32 s57, s59, 36864
    buffer_load_dwordx4 v9, s[12:15], s57 offen lds
    s_add_u32 s56, s46, s47
    s_add_u32 m0, s56, 8192
    s_add_u32 s57, s59, 73728
    buffer_load_dwordx4 v9, s[12:15], s57 offen lds
    s_add_u32 s56, s46, s47
    s_add_u32 m0, s56, 12288
    s_add_u32 s57, s59, 0
    buffer_load_dwordx4 v9, s[16:19], s57 offen lds
    s_add_u32 s56, s46, s47
    s_add_u32 m0, s56, 16384
    s_add_u32 s57, s59, 36864
    buffer_load_dwordx4 v9, s[16:19], s57 offen lds
    s_add_u32 s56, s46, s47
    s_add_u32 m0, s56, 20480
    s_add_u32 s57, s59, 73728
    buffer_load_dwordx4 v9, s[16:19], s57 offen lds
    s_add_u32 s59, s59, 128
    s_add_u32 s54, s54, 128
    s_add_u32 s47, s47, 40960
    s_cmp_eq_u32 s47, 163840
    s_cselect_b32 s47, 0, s47
    s_sub_u32 s58, s58, 1
    s_cmp_lg_u32 s58, 0
    s_cbranch_scc1 L_k1_bploop
    s_waitcnt vmcnt(10)
    s_barrier
    s_waitcnt vmcnt(0)
    s_barrier
    s_endpgm
L_k1_cons:
    s_and_b32 s36, s3, 1
    s_lshr_b32 s37, s3, 1
    v_and_b32 v3, 31, v2
    v_lshrrev_b32 v4, 5, v2
    v_bfe_u32 v5, v3, 2, 1
    v_lshlrev_b32 v5, 4, v5
    v_lshrrev_b32 v6, 3, v3
    v_lshlrev_b32 v6, 2, v6
    v_add_u32 v5, v5, v6
    v_and_b32 v6, 3, v3
    v_add_u32 v5, v5, v6
    s_lshl_b32 s38, s36, 6
    v_add_u32 v5, s38, v5
    v_bfe_u32 v6, v5, 1, 3
    v_lshlrev_b32 v5, 7, v5
    v_add_u32 v7, 0, v4
    v_xor_b32 v7, v7, v6
    v_lshl_add_u32 v48, v7, 4, v5
    v_add_u32 v7, 2, v4
    v_xor_b32 v7, v7, v6
    v_lshl_add_u32 v49, v7, 4, v5
    v_add_u32 v7, 4, v4
    v_xor_b32 v7, v7, v6
    v_lshl_add_u32 v50, v7, 4, v5
    v_add_u32 v7, 6, v4
    v_xor_b32 v7, v7, v6
    v_lshl_add_u32 v51, v7, 4, v5
    v_mov_b32 v64, 0
    v_mov_b32 v65, 0
    v_mov_b32 v66, 0
    v_mov_b32 v67, 0
    v_mov_b32 v68, 0
    v_mov_b32 v69, 0
    v_mov_b32 v70, 0
    v_mov_b32 v71, 0
    v_mov_b32 v72, 0
    v_mov_b32 v73, 0
    v_mov_b32 v74, 0
    v_mov_b32 v75, 0
    v_mov_b32 v76, 0
    v_mov_b32 v77, 0
    v_mov_b32 v78, 0
    v_mov_b32 v79, 0
    v_mov_b32 v80, 0
    v_mov_b32 v81, 0
    v_mov_b32 v82, 0
    v_mov_b32 v83, 0
    v_mov_b32 v84, 0
    v_mov_b32 v85, 0
    v_mov_b32 v86, 0
    v_mov_b32 v87, 0
    v_mov_b32 v88, 0
    v_mov_b32 v89, 0
    v_mov_b32 v90, 0
    v_mov_b32 v91, 0
    v_mov_b32 v92, 0
    v_mov_b32 v93, 0
    v_mov_b32 v94, 0
    v_mov_b32 v95, 0
    v_mov_b32 v96, 0
    v_mov_b32 v97, 0
    v_mov_b32 v98, 0
    v_mov_b32 v99, 0
    v_mov_b32 v100, 0
    v_mov_b32 v101, 0
    v_mov_b32 v102, 0
    v_mov_b32 v103, 0
    v_mov_b32 v104, 0
    v_mov_b32 v105, 0
    v_mov_b32 v106, 0
    v_mov_b32 v107, 0
    v_mov_b32 v108, 0
    v_mov_b32 v109, 0
    v_mov_b32 v110, 0
    v_mov_b32 v111, 0
    v_mov_b32 v112, 0
    v_mov_b32 v113, 0
    v_mov_b32 v114, 0
    v_mov_b32 v115, 0
    v_mov_b32 v116, 0
    v_mov_b32 v117, 0
    v_mov_b32 v118, 0
    v_mov_b32 v119, 0
    v_mov_b32 v120, 0
    v_mov_b32 v121, 0
    v_mov_b32 v122, 0
    v_mov_b32 v123, 0
    v_mov_b32 v124, 0
    v_mov_b32 v125, 0
    v_mov_b32 v126, 0
    v_mov_b32 v127, 0
    v_mov_b32 v128, 0
    v_mov_b32 v129, 0
    v_mov_b32 v130, 0
    v_mov_b32 v131, 0
    v_mov_b32 v132, 0
    v_mov_b32 v133, 0
    v_mov_b32 v134, 0
    v_mov_b32 v135, 0
    v_mov_b32 v136, 0
    v_mov_b32 v137, 0
    v_mov_b32 v138, 0
    v_mov_b32 v139, 0
    v_mov_b32 v140, 0
    v_mov_b32 v141, 0
    v_mov_b32 v142, 0
    v_mov_b32 v143, 0
    v_mov_b32 v144, 0
    v_mov_b32 v145, 0
    v_mov_b32 v146, 0
    v_mov_b32 v147, 0
    v_mov_b32 v148, 0
    v_mov_b32 v149, 0
    v_mov_b32 v150, 0
    v_mov_b32 v151, 0
    v_mov_b32 v152, 0
    v_mov_b32 v153, 0
    v_mov_b32 v154, 0
    v_mov_b32 v155, 0
    v_mov_b32 v156, 0
    v_mov_b32 v157, 0
    v_mov_b32 v158, 0
    v_mov_b32 v159, 0
    s_mul_i32 s39, s3, 12288
    s_add_u32 s39, s39, 40960
    v_bfe_u32 v5, v3, 1, 2
    v_lshlrev_b32 v6, 1, v4
    v_xor_b32 v6, v6, v5
    v_lshlrev_b32 v7, 6, v3
    v_add_u32 v7, s39, v7
    v_lshl_add_u32 v56, v6, 4, v7
    v_xor_b32 v6, 1, v6
    v_lshl_add_u32 v57, v6, 4, v7
    v_lshrrev_b32 v58, 2, v2
    v_and_b32 v59, 3, v2
    s_cmp_eq_u32 s4, 1
    s_cbranch_scc1 L_k1_euc
    s_mul_i32 s61, s6, 11
    s_lshr_b32 s61, s61, 5
    s_mul_i32 s62, s61, 3
    s_sub_u32 s62, s6, s62
    s_mul_i32 s62, s62, 192
    s_mul_i32 s63, s37, 96
    s_add_u32 s62, s62, s63
    s_mov_b32 s60, 1.0
    s_mov_b32 s63, 0x3eae1a93
    s_cmp_eq_u32 s61, 0
    s_cselect_b32 s60, s63, s60
    s_mov_b32 s64, 0
    s_cmp_eq_u32 s61, 1
    s_cselect_b32 s64, 2359296, s64
    s_mov_b32 s65, 73728
    s_movk_i32 s66, 1152
    s_cmp_eq_u32 s61, 2
    s_cselect_b32 s64, 4718592, s64
    s_cselect_b32 s65, 77824, s65
    s_cselect_b32 s66, 1216, s66
    s_cselect_b32 s67, 3, 0
    s_mov_b32 s68, 911
    v_add_u32 v5, 0, v58
    v_add_u32 v5, s62, v5
    v_mul_u32_u24 v6, s68, v5
    v_lshrrev_b32 v6, 14, v6
    v_mul_u32_u24 v7, 18, v6
    v_sub_u32 v7, v5, v7
    v_mul_lo_u32 v6, v6, s65
    v_lshl_add_u32 v6, v7, 6, v6
    v_lshl_add_u32 v166, v59, 4, v6
    v_bfe_u32 v60, v7, 2, 2
    v_and_b32 v60, s67, v60
    v_xor_b32 v60, v60, v59
    v_add_u32 v61, 0, v58
    v_bfe_u32 v62, v61, 1, 2
    v_xor_b32 v60, v60, v62
    v_lshlrev_b32 v61, 6, v61
    v_lshl_add_u32 v61, v60, 4, v61
    v_add_u32 v160, s39, v61
    v_cmp_eq_u32 vcc, 17, v7
    v_add_u32 v61, 64, v166
    v_mov_b32 v62, 0x7f000000
    v_cndmask_b32 v172, v62, v61, vcc
    v_add_u32 v5, 16, v58
    v_add_u32 v5, s62, v5
    v_mul_u32_u24 v6, s68, v5
    v_lshrrev_b32 v6, 14, v6
    v_mul_u32_u24 v7, 18, v6
    v_sub_u32 v7, v5, v7
    v_mul_lo_u32 v6, v6, s65
    v_lshl_add_u32 v6, v7, 6, v6
    v_lshl_add_u32 v167, v59, 4, v6
    v_bfe_u32 v60, v7, 2, 2
    v_and_b32 v60, s67, v60
    v_xor_b32 v60, v60, v59
    v_add_u32 v61, 16, v58
    v_bfe_u32 v62, v61, 1, 2
    v_xor_b32 v60, v60, v62
    v_lshlrev_b32 v61, 6, v61
    v_lshl_add_u32 v61, v60, 4, v61
    v_add_u32 v161, s39, v61
    v_cmp_eq_u32 vcc, 17, v7
    v_add_u32 v61, 64, v167
    v_mov_b32 v62, 0x7f000000
    v_cndmask_b32 v173, v62, v61, vcc
    v_add_u32 v5, 32, v58
    v_add_u32 v5, s62, v5
    v_mul_u32_u24 v6, s68, v5
    v_lshrrev_b32 v6, 14, v6
    v_mul_u32_u24 v7, 18, v6
    v_sub_u32 v7, v5, v7
    v_mul_lo_u32 v6, v6, s65
    v_lshl_add_u32 v6, v7, 6, v6
    v_lshl_add_u32 v168, v59, 4, v6
    v_bfe_u32 v60, v7, 2, 2
    v_and_b32 v60, s67, v60
    v_xor_b32 v60, v60, v59
    v_add_u32 v61, 0, v58
    v_bfe_u32 v62, v61, 1, 2
    v_xor_b32 v60, v60, v62
    v_lshlrev_b32 v61, 6, v61
    v_lshl_add_u32 v61, v60, 4, v61
    v_add_u32 v162, s39, v61
    v_cmp_eq_u32 vcc, 17, v7
    v_add_u32 v61, 64, v168
    v_mov_b32 v62, 0x7f000000
    v_cndmask_b32 v174, v62, v61, vcc
    v_add_u32 v5, 48, v58
    v_add_u32 v5, s62, v5
    v_mul_u32_u24 v6, s68, v5
    v_lshrrev_b32 v6, 14, v6
    v_mul_u32_u24 v7, 18, v6
    v_sub_u32 v7, v5, v7
    v_mul_lo_u32 v6, v6, s65
    v_lshl_add_u32 v6, v7, 6, v6
    v_lshl_add_u32 v169, v59, 4, v6
    v_bfe_u32 v60, v7, 2, 2
    v_and_b32 v60, s67, v60
    v_xor_b32 v60, v60, v59
    v_add_u32 v61, 16, v58
    v_bfe_u32 v62, v61, 1, 2
    v_xor_b32 v60, v60, v62
    v_lshlrev_b32 v61, 6, v61
    v_lshl_add_u32 v61, v60, 4, v61
    v_add_u32 v163, s39, v61
    v_cmp_eq_u32 vcc, 17, v7
    v_add_u32 v61, 64, v169
    v_mov_b32 v62, 0x7f000000
    v_cndmask_b32 v175, v62, v61, vcc
    v_add_u32 v5, 64, v58
    v_add_u32 v5, s62, v5
    v_mul_u32_u24 v6, s68, v5
    v_lshrrev_b32 v6, 14, v6
    v_mul_u32_u24 v7, 18, v6
    v_sub_u32 v7, v5, v7
    v_mul_lo_u32 v6, v6, s65
    v_lshl_add_u32 v6, v7, 6, v6
    v_lshl_add_u32 v170, v59, 4, v6
    v_bfe_u32 v60, v7, 2, 2
    v_and_b32 v60, s67, v60
    v_xor_b32 v60, v60, v59
    v_add_u32 v61, 0, v58
    v_bfe_u32 v62, v61, 1, 2
    v_xor_b32 v60, v60, v62
    v_lshlrev_b32 v61, 6, v61
    v_lshl_add_u32 v61, v60, 4, v61
    v_add_u32 v164, s39, v61
    v_cmp_eq_u32 vcc, 17, v7
    v_add_u32 v61, 64, v170
    v_mov_b32 v62, 0x7f000000
    v_cndmask_b32 v176, v62, v61, vcc
    v_add_u32 v5, 80, v58
    v_add_u32 v5, s62, v5
    v_mul_u32_u24 v6, s68, v5
    v_lshrrev_b32 v6, 14, v6
    v_mul_u32_u24 v7, 18, v6
    v_sub_u32 v7, v5, v7
    v_mul_lo_u32 v6, v6, s65
    v_lshl_add_u32 v6, v7, 6, v6
    v_lshl_add_u32 v171, v59, 4, v6
    v_bfe_u32 v60, v7, 2, 2
    v_and_b32 v60, s67, v60
    v_xor_b32 v60, v60, v59
    v_add_u32 v61, 16, v58
    v_bfe_u32 v62, v61, 1, 2
    v_xor_b32 v60, v60, v62
    v_lshlrev_b32 v61, 6, v61
    v_lshl_add_u32 v61, v60, 4, v61
    v_add_u32 v165, s39, v61
    v_cmp_eq_u32 vcc, 17, v7
    v_add_u32 v61, 64, v171
    v_mov_b32 v62, 0x7f000000
    v_cndmask_b32 v177, v62, v61, vcc
    s_branch L_k1_edc
L_k1_euc:
    s_mul_i32 s62, s6, 192
    s_mul_i32 s63, s37, 96
    s_add_u32 s62, s62, s63
    s_mov_b32 s64, 7208960
    s_mov_b32 s66, 73728
    s_mov_b32 s61, 3
    s_mov_b32 s60, 1.0
    v_add_u32 v5, 0, v58
    v_add_u32 v5, s62, v5
    v_lshlrev_b32 v5, 6, v5
    v_lshl_add_u32 v166, v59, 4, v5
    v_add_u32 v61, 0, v58
    v_bfe_u32 v62, v61, 1, 2
    v_xor_b32 v60, v59, v62
    v_lshlrev_b32 v61, 6, v61
    v_lshl_add_u32 v61, v60, 4, v61
    v_add_u32 v160, s39, v61
    v_mov_b32 v172, 0x7f000000
    v_add_u32 v5, 16, v58
    v_add_u32 v5, s62, v5
    v_lshlrev_b32 v5, 6, v5
    v_lshl_add_u32 v167, v59, 4, v5
    v_add_u32 v61, 16, v58
    v_bfe_u32 v62, v61, 1, 2
    v_xor_b32 v60, v59, v62
    v_lshlrev_b32 v61, 6, v61
    v_lshl_add_u32 v61, v60, 4, v61
    v_add_u32 v161, s39, v61
    v_mov_b32 v173, 0x7f000000
    v_add_u32 v5, 32, v58
    v_add_u32 v5, s62, v5
    v_lshlrev_b32 v5, 6, v5
    v_lshl_add_u32 v168, v59, 4, v5
    v_add_u32 v61, 0, v58
    v_bfe_u32 v62, v61, 1, 2
    v_xor_b32 v60, v59, v62
    v_lshlrev_b32 v61, 6, v61
    v_lshl_add_u32 v61, v60, 4, v61
    v_add_u32 v162, s39, v61
    v_mov_b32 v174, 0x7f000000
    v_add_u32 v5, 48, v58
    v_add_u32 v5, s62, v5
    v_lshlrev_b32 v5, 6, v5
    v_lshl_add_u32 v169, v59, 4, v5
    v_add_u32 v61, 16, v58
    v_bfe_u32 v62, v61, 1, 2
    v_xor_b32 v60, v59, v62
    v_lshlrev_b32 v61, 6, v61
    v_lshl_add_u32 v61, v60, 4, v61
    v_add_u32 v163, s39, v61
    v_mov_b32 v175, 0x7f000000
    v_add_u32 v5, 64, v58
    v_add_u32 v5, s62, v5
    v_lshlrev_b32 v5, 6, v5
    v_lshl_add_u32 v170, v59, 4, v5
    v_add_u32 v61, 0, v58
    v_bfe_u32 v62, v61, 1, 2
    v_xor_b32 v60, v59, v62
    v_lshlrev_b32 v61, 6, v61
    v_lshl_add_u32 v61, v60, 4, v61
    v_add_u32 v164, s39, v61
    v_mov_b32 v176, 0x7f000000
    v_add_u32 v5, 80, v58
    v_add_u32 v5, s62, v5
    v_lshlrev_b32 v5, 6, v5
    v_lshl_add_u32 v171, v59, 4, v5
    v_add_u32 v61, 16, v58
    v_bfe_u32 v62, v61, 1, 2
    v_xor_b32 v60, v59, v62
    v_lshlrev_b32 v61, 6, v61
    v_lshl_add_u32 v61, v60, 4, v61
    v_add_u32 v165, s39, v61
    v_mov_b32 v177, 0x7f000000
L_k1_edc:
    s_lshl_b32 s38, s5, 2
    s_lshl_b32 s39, s36, 1
    s_add_u32 s38, s38, s39
    s_mul_i32 s69, s38, s66
    s_add_u32 s69, s69, s64
    s_add_u32 s70, s69, s66
    s_waitcnt lgkmcnt(0)
    s_mov_b32 s20, s40
    s_and_b32 s21, s41, 0xffff
    s_mov_b32 s22, 16586240
    s_mov_b32 s23, 0x20000
    s_cmp_eq_u32 s4, 1
    s_cbranch_scc1 L_k1_cbu
    v_lshrrev_b32 v5, 4, v2
    v_lshrrev_b32 v6, 1, v5
    v_bfe_u32 v7, v2, 2, 2
    v_and_b32 v60, 3, v2
    v_lshl_add_u32 v6, v6, 3, v7
    v_mul_u32_u24 v6, 384, v6
    v_add_u32 v6, 16384, v6
    v_and_b32 v61, 1, v60
    v_lshl_add_u32 v6, v61, 3, v6
    v_and_b32 v5, 1, v5
    v_lshlrev_b32 v5, 1, v5
    v_lshrrev_b32 v60, 1, v60
    v_add_u32 v5, v5, v60
    s_mul_i32 s38, s37, 12
    v_add_u32 v5, s38, v5
    v_bfe_u32 v7, v7, 1, 1
    v_lshlrev_b32 v7, 2, v7
    v_add_u32 v60, 0, v5
    v_xor_b32 v60, v60, v7
    v_lshl_add_u32 v52, v60, 4, v6
    v_add_u32 v60, 4, v5
    v_xor_b32 v60, v60, v7
    v_lshl_add_u32 v53, v60, 4, v6
    v_add_u32 v60, 8, v5
    v_xor_b32 v60, v60, v7
    v_lshl_add_u32 v54, v60, 4, v6
    s_mov_b32 s30, 0
    s_mov_b32 s32, 40960
    s_mov_b32 s33, -122880
    s_mov_b32 s34, 9
    s_mov_b32 s31, s32
    s_barrier
    ds_read_b128 v[8:11], v48 offset:0
    ds_read_b64_tr_b16 v[24:25], v52 offset:0
    ds_read_b64_tr_b16 v[26:27], v52 offset:1536
    ds_read_b64_tr_b16 v[28:29], v53 offset:0
    ds_read_b64_tr_b16 v[30:31], v53 offset:1536
    ds_read_b64_tr_b16 v[32:33], v54 offset:0
    ds_read_b64_tr_b16 v[34:35], v54 offset:1536
    ds_read_b128 v[12:15], v48 offset:4096
L_cons_qkv:
    s_waitcnt lgkmcnt(5)
    v_mfma_f32_32x32x16_bf16 v[64:79], v[8:11], v[24:27], v[64:79]
    ds_read_b128 v[16:19], v49 offset:0
    ds_read_b64_tr_b16 v[36:37], v52 offset:6144
    ds_read_b64_tr_b16 v[38:39], v52 offset:7680
    s_waitcnt lgkmcnt(6)
    v_mfma_f32_32x32x16_bf16 v[80:95], v[8:11], v[28:31], v[80:95]
    ds_read_b64_tr_b16 v[40:41], v53 offset:6144
    ds_read_b64_tr_b16 v[42:43], v53 offset:7680
    ds_read_b64_tr_b16 v[44:45], v54 offset:6144
    s_waitcnt lgkmcnt(7)
    v_mfma_f32_32x32x16_bf16 v[96:111], v[8:11], v[32:35], v[96:111]
    ds_read_b64_tr_b16 v[46:47], v54 offset:7680
    ds_read_b128 v[20:23], v49 offset:4096
    s_waitcnt lgkmcnt(8)
    v_mfma_f32_32x32x16_bf16 v[112:127], v[12:15], v[24:27], v[112:127]
    v_mfma_f32_32x32x16_bf16 v[128:143], v[12:15], v[28:31], v[128:143]
    v_add_u32 v48, s31, v48
    v_add_u32 v49, s31, v49
    v_mfma_f32_32x32x16_bf16 v[144:159], v[12:15], v[32:35], v[144:159]
    s_waitcnt lgkmcnt(5)
    v_mfma_f32_32x32x16_bf16 v[64:79], v[16:19], v[36:39], v[64:79]
    ds_read_b128 v[8:11], v50 offset:0
    ds_read_b64_tr_b16 v[24:25], v52 offset:12288
    ds_read_b64_tr_b16 v[26:27], v52 offset:13824
    s_waitcnt lgkmcnt(6)
    v_mfma_f32_32x32x16_bf16 v[80:95], v[16:19], v[40:43], v[80:95]
    ds_read_b64_tr_b16 v[28:29], v53 offset:12288
    ds_read_b64_tr_b16 v[30:31], v53 offset:13824
    ds_read_b64_tr_b16 v[32:33], v54 offset:12288
    s_waitcnt lgkmcnt(7)
    v_mfma_f32_32x32x16_bf16 v[96:111], v[16:19], v[44:47], v[96:111]
    ds_read_b64_tr_b16 v[34:35], v54 offset:13824
    ds_read_b128 v[12:15], v50 offset:4096
    s_waitcnt lgkmcnt(8)
    v_mfma_f32_32x32x16_bf16 v[112:127], v[20:23], v[36:39], v[112:127]
    v_mfma_f32_32x32x16_bf16 v[128:143], v[20:23], v[40:43], v[128:143]
    v_add_u32 v50, s31, v50
    v_mfma_f32_32x32x16_bf16 v[144:159], v[20:23], v[44:47], v[144:159]
    s_cmp_eq_u32 s34, 1
    s_cbranch_scc1 L_nb_qkv
    s_barrier
L_nb_qkv:
    s_waitcnt lgkmcnt(5)
    v_mfma_f32_32x32x16_bf16 v[64:79], v[8:11], v[24:27], v[64:79]
    ds_read_b128 v[16:19], v51 offset:0
    ds_read_b64_tr_b16 v[36:37], v52 offset:18432
    ds_read_b64_tr_b16 v[38:39], v52 offset:19968
    s_waitcnt lgkmcnt(6)
    v_mfma_f32_32x32x16_bf16 v[80:95], v[8:11], v[28:31], v[80:95]
    ds_read_b64_tr_b16 v[40:41], v53 offset:18432
    ds_read_b64_tr_b16 v[42:43], v53 offset:19968
    ds_read_b64_tr_b16 v[44:45], v54 offset:18432
    s_waitcnt lgkmcnt(7)
    v_mfma_f32_32x32x16_bf16 v[96:111], v[8:11], v[32:35], v[96:111]
    ds_read_b64_tr_b16 v[46:47], v54 offset:19968
    ds_read_b128 v[20:23], v51 offset:4096
    s_waitcnt lgkmcnt(8)
    v_mfma_f32_32x32x16_bf16 v[112:127], v[12:15], v[24:27], v[112:127]
    v_mfma_f32_32x32x16_bf16 v[128:143], v[12:15], v[28:31], v[128:143]
    v_add_u32 v51, s31, v51
    v_add_u32 v52, s31, v52
    v_add_u32 v53, s31, v53
    v_add_u32 v54, s31, v54
    v_mfma_f32_32x32x16_bf16 v[144:159], v[12:15], v[32:35], v[144:159]
    s_waitcnt lgkmcnt(5)
    v_mfma_f32_32x32x16_bf16 v[64:79], v[16:19], v[36:39], v[64:79]
    ds_read_b128 v[8:11], v48 offset:0
    ds_read_b64_tr_b16 v[24:25], v52 offset:0
    ds_read_b64_tr_b16 v[26:27], v52 offset:1536
    s_waitcnt lgkmcnt(6)
    v_mfma_f32_32x32x16_bf16 v[80:95], v[16:19], v[40:43], v[80:95]
    ds_read_b64_tr_b16 v[28:29], v53 offset:0
    ds_read_b64_tr_b16 v[30:31], v53 offset:1536
    ds_read_b64_tr_b16 v[32:33], v54 offset:0
    s_waitcnt lgkmcnt(7)
    v_mfma_f32_32x32x16_bf16 v[96:111], v[16:19], v[44:47], v[96:111]
    ds_read_b64_tr_b16 v[34:35], v54 offset:1536
    ds_read_b128 v[12:15], v48 offset:4096
    s_waitcnt lgkmcnt(8)
    v_mfma_f32_32x32x16_bf16 v[112:127], v[20:23], v[36:39], v[112:127]
    v_mfma_f32_32x32x16_bf16 v[128:143], v[20:23], v[40:43], v[128:143]
    s_add_u32 s30, s30, 1
    s_cmp_eq_u32 s30, 3
    s_cselect_b32 s31, s33, s32
    s_cmp_eq_u32 s30, 4
    s_cselect_b32 s30, 0, s30
    v_mfma_f32_32x32x16_bf16 v[144:159], v[20:23], v[44:47], v[144:159]
    s_sub_u32 s34, s34, 1
    s_cmp_lg_u32 s34, 0
    s_cbranch_scc1 L_cons_qkv
    s_waitcnt lgkmcnt(0)
L_k1_epiQKV:
    s_nop 7
    s_nop 3
    s_cmp_lg_u32 s61, 0
    s_cbranch_scc1 L_k1_noscQKV
    s_mov_b32 s77, s60
    s_mov_b32 s76, s60
    v_pk_mul_f32 v[64:65], v[64:65], s[76:77]
    v_pk_mul_f32 v[66:67], v[66:67], s[76:77]
    v_pk_mul_f32 v[68:69], v[68:69], s[76:77]
    v_pk_mul_f32 v[70:71], v[70:71], s[76:77]
    v_pk_mul_f32 v[72:73], v[72:73], s[76:77]
    v_pk_mul_f32 v[74:75], v[74:75], s[76:77]
    v_pk_mul_f32 v[76:77], v[76:77], s[76:77]
    v_pk_mul_f32 v[78:79], v[78:79], s[76:77]
    v_pk_mul_f32 v[80:81], v[80:81], s[76:77]
    v_pk_mul_f32 v[82:83], v[82:83], s[76:77]
    v_pk_mul_f32 v[84:85], v[84:85], s[76:77]
    v_pk_mul_f32 v[86:87], v[86:87], s[76:77]
    v_pk_mul_f32 v[88:89], v[88:89], s[76:77]
    v_pk_mul_f32 v[90:91], v[90:91], s[76:77]
    v_pk_mul_f32 v[92:93], v[92:93], s[76:77]
    v_pk_mul_f32 v[94:95], v[94:95], s[76:77]
    v_pk_mul_f32 v[96:97], v[96:97], s[76:77]
    v_pk_mul_f32 v[98:99], v[98:99], s[76:77]
    v_pk_mul_f32 v[100:101], v[100:101], s[76:77]
    v_pk_mul_f32 v[102:103], v[102:103], s[76:77]
    v_pk_mul_f32 v[104:105], v[104:105], s[76:77]
    v_pk_mul_f32 v[106:107], v[106:107], s[76:77]
    v_pk_mul_f32 v[108:109], v[108:109], s[76:77]
    v_pk_mul_f32 v[110:111], v[110:111], s[76:77]
    v_pk_mul_f32 v[112:113], v[112:113], s[76:77]
    v_pk_mul_f32 v[114:115], v[114:115], s[76:77]
    v_pk_mul_f32 v[116:117], v[116:117], s[76:77]
    v_pk_mul_f32 v[118:119], v[118:119], s[76:77]
    v_pk_mul_f32 v[120:121], v[120:121], s[76:77]
    v_pk_mul_f32 v[122:123], v[122:123], s[76:77]
    v_pk_mul_f32 v[124:125], v[124:125], s[76:77]
    v_pk_mul_f32 v[126:127], v[126:127], s[76:77]
    v_pk_mul_f32 v[128:129], v[128:129], s[76:77]
    v_pk_mul_f32 v[130:131], v[130:131], s[76:77]
    v_pk_mul_f32 v[132:133], v[132:133], s[76:77]
    v_pk_mul_f32 v[134:135], v[134:135], s[76:77]
    v_pk_mul_f32 v[136:137], v[136:137], s[76:77]
    v_pk_mul_f32 v[138:139], v[138:139], s[76:77]
    v_pk_mul_f32 v[140:141], v[140:141], s[76:77]
    v_pk_mul_f32 v[142:143], v[142:143], s[76:77]
    v_pk_mul_f32 v[144:145], v[144:145], s[76:77]
    v_pk_mul_f32 v[146:147], v[146:147], s[76:77]
    v_pk_mul_f32 v[148:149], v[148:149], s[76:77]
    v_pk_mul_f32 v[150:151], v[150:151], s[76:77]
    v_pk_mul_f32 v[152:153], v[152:153], s[76:77]
    v_pk_mul_f32 v[154:155], v[154:155], s[76:77]
    v_pk_mul_f32 v[156:157], v[156:157], s[76:77]
    v_pk_mul_f32 v[158:159], v[158:159], s[76:77]
L_k1_noscQKV:
    v_cvt_pk_bf16_f32 v8, v64, v65
    v_cvt_pk_bf16_f32 v9, v66, v67
    v_cvt_pk_bf16_f32 v10, v68, v69
    v_cvt_pk_bf16_f32 v11, v70, v71
    v_cvt_pk_bf16_f32 v12, v72, v73
    v_cvt_pk_bf16_f32 v13, v74, v75
    v_cvt_pk_bf16_f32 v14, v76, v77
    v_cvt_pk_bf16_f32 v15, v78, v79
    ds_write_b128 v56, v[8:11] offset:0
    ds_write_b128 v57, v[12:15] offset:0
    v_cvt_pk_bf16_f32 v16, v80, v81
    v_cvt_pk_bf16_f32 v17, v82, v83
    v_cvt_pk_bf16_f32 v18, v84, v85
    v_cvt_pk_bf16_f32 v19, v86, v87
    v_cvt_pk_bf16_f32 v20, v88, v89
    v_cvt_pk_bf16_f32 v21, v90, v91
    v_cvt_pk_bf16_f32 v22, v92, v93
    v_cvt_pk_bf16_f32 v23, v94, v95
    ds_write_b128 v56, v[16:19] offset:2048
    ds_write_b128 v57, v[20:23] offset:2048
    s_waitcnt lgkmcnt(2)
    ds_read_b128 v[32:35], v160 offset:0
    ds_read_b128 v[36:39], v161 offset:0
    v_cvt_pk_bf16_f32 v24, v96, v97
    v_cvt_pk_bf16_f32 v25, v98, v99
    v_cvt_pk_bf16_f32 v26, v100, v101
    v_cvt_pk_bf16_f32 v27, v102, v103
    v_cvt_pk_bf16_f32 v28, v104, v105
    v_cvt_pk_bf16_f32 v29, v106, v107
    v_cvt_pk_bf16_f32 v30, v108, v109
    v_cvt_pk_bf16_f32 v31, v110, v111
    ds_write_b128 v56, v[24:27] offset:4096
    ds_write_b128 v57, v[28:31] offset:4096
    s_waitcnt lgkmcnt(4)
    ds_read_b128 v[40:43], v162 offset:2048
    ds_read_b128 v[44:47], v163 offset:2048
    s_waitcnt lgkmcnt(5)
    buffer_store_dwordx4 v[32:35], v166, s[20:23], s69 offen sc1
    s_waitcnt lgkmcnt(4)
    buffer_store_dwordx4 v[36:39], v167, s[20:23], s69 offen sc1
    v_cvt_pk_bf16_f32 v8, v112, v113
    v_cvt_pk_bf16_f32 v9, v114, v115
    v_cvt_pk_bf16_f32 v10, v116, v117
    v_cvt_pk_bf16_f32 v11, v118, v119
    v_cvt_pk_bf16_f32 v12, v120, v121
    v_cvt_pk_bf16_f32 v13, v122, v123
    v_cvt_pk_bf16_f32 v14, v124, v125
    v_cvt_pk_bf16_f32 v15, v126, v127
    ds_write_b128 v56, v[8:11] offset:6144
    ds_write_b128 v57, v[12:15] offset:6144
    s_waitcnt lgkmcnt(4)
    ds_read_b128 v[48:51], v164 offset:4096
    ds_read_b128 v[52:55], v165 offset:4096
    s_waitcnt lgkmcnt(5)
    buffer_store_dwordx4 v[40:43], v168, s[20:23], s69 offen sc1
    s_waitcnt lgkmcnt(4)
    buffer_store_dwordx4 v[44:47], v169, s[20:23], s69 offen sc1
    v_cvt_pk_bf16_f32 v16, v128, v129
    v_cvt_pk_bf16_f32 v17, v130, v131
    v_cvt_pk_bf16_f32 v18, v132, v133
    v_cvt_pk_bf16_f32 v19, v134, v135
    v_cvt_pk_bf16_f32 v20, v136, v137
    v_cvt_pk_bf16_f32 v21, v138, v139
    v_cvt_pk_bf16_f32 v22, v140, v141
    v_cvt_pk_bf16_f32 v23, v142, v143
    ds_write_b128 v56, v[16:19] offset:8192
    ds_write_b128 v57, v[20:23] offset:8192
    s_waitcnt lgkmcnt(4)
    ds_read_b128 v[32:35], v160 offset:6144
    ds_read_b128 v[36:39], v161 offset:6144
    s_waitcnt lgkmcnt(5)
    buffer_store_dwordx4 v[48:51], v170, s[20:23], s69 offen sc1
    s_waitcnt lgkmcnt(4)
    buffer_store_dwordx4 v[52:55], v171, s[20:23], s69 offen sc1
    v_cvt_pk_bf16_f32 v24, v144, v145
    v_cvt_pk_bf16_f32 v25, v146, v147
    v_cvt_pk_bf16_f32 v26, v148, v149
    v_cvt_pk_bf16_f32 v27, v150, v151
    v_cvt_pk_bf16_f32 v28, v152, v153
    v_cvt_pk_bf16_f32 v29, v154, v155
    v_cvt_pk_bf16_f32 v30, v156, v157
    v_cvt_pk_bf16_f32 v31, v158, v159
    ds_write_b128 v56, v[24:27] offset:10240
    ds_write_b128 v57, v[28:31] offset:10240
    s_waitcnt lgkmcnt(4)
    ds_read_b128 v[40:43], v162 offset:8192
    ds_read_b128 v[44:47], v163 offset:8192
    s_waitcnt lgkmcnt(5)
    buffer_store_dwordx4 v[32:35], v166, s[20:23], s70 offen sc1
    s_waitcnt lgkmcnt(4)
    buffer_store_dwordx4 v[36:39], v167, s[20:23], s70 offen sc1
    s_waitcnt lgkmcnt(2)
    ds_read_b128 v[48:51], v164 offset:10240
    ds_read_b128 v[52:55], v165 offset:10240
    s_waitcnt lgkmcnt(3)
    buffer_store_dwordx4 v[40:43], v168, s[20:23], s70 offen sc1
    s_waitcnt lgkmcnt(2)
    buffer_store_dwordx4 v[44:47], v169, s[20:23], s70 offen sc1
    s_waitcnt lgkmcnt(1)
    buffer_store_dwordx4 v[48:51], v170, s[20:23], s70 offen sc1
    s_waitcnt lgkmcnt(0)
    buffer_store_dwordx4 v[52:55], v171, s[20:23], s70 offen sc1
    s_cmp_lg_u32 s61, 2
    s_cbranch_scc1 L_k1_finQKV
    v_mov_b32 v24, 0x3f803f80
    v_mov_b32 v25, 0x3f803f80
    v_mov_b32 v26, 0x3f803f80
    v_mov_b32 v27, 0x3f803f80
    s_nop 1
    buffer_store_dwordx4 v[24:27], v172, s[20:23], s69 offen sc1
    buffer_store_dwordx4 v[24:27], v173, s[20:23], s69 offen sc1
    buffer_store_dwordx4 v[24:27], v174, s[20:23], s69 offen sc1
    buffer_store_dwordx4 v[24:27], v175, s[20:23], s69 offen sc1
    buffer_store_dwordx4 v[24:27], v176, s[20:23], s69 offen sc1
    buffer_store_dwordx4 v[24:27], v177, s[20:23], s69 offen sc1
    buffer_store_dwordx4 v[24:27], v172, s[20:23], s70 offen sc1
    buffer_store_dwordx4 v[24:27], v173, s[20:23], s70 offen sc1
    buffer_store_dwordx4 v[24:27], v174, s[20:23], s70 offen sc1
    buffer_store_dwordx4 v[24:27], v175, s[20:23], s70 offen sc1
    buffer_store_dwordx4 v[24:27], v176, s[20:23], s70 offen sc1
    buffer_store_dwordx4 v[24:27], v177, s[20:23], s70 offen sc1
L_k1_finQKV:
    s_endpgm
L_k1_cbu:
    s_mul_i32 s38, s37, 96
    v_add_u32 v5, s38, v3
    v_bfe_u32 v6, v5, 1, 3
    v_lshlrev_b32 v5, 7, v5
    v_add_u32 v5, 16384, v5
    v_add_u32 v7, 0, v4
    v_xor_b32 v7, v7, v6
    v_lshl_add_u32 v52, v7, 4, v5
    v_add_u32 v7, 2, v4
    v_xor_b32 v7, v7, v6
    v_lshl_add_u32 v53, v7, 4, v5
    v_add_u32 v7, 4, v4
    v_xor_b32 v7, v7, v6
    v_lshl_add_u32 v54, v7, 4, v5
    v_add_u32 v7, 6, v4
    v_xor_b32 v7, v7, v6
    v_lshl_add_u32 v55, v7, 4, v5
    s_mov_b32 s30, 0
    s_mov_b32 s32, 40960
    s_mov_b32 s33, -122880
    s_mov_b32 s34, 9
    s_mov_b32 s31, s32
    s_barrier
    ds_read_b128 v[8:11], v48 offset:0
    ds_read_b128 v[24:27], v52 offset:0
    ds_read_b128 v[28:31], v52 offset:4096
    ds_read_b128 v[32:35], v52 offset:8192
    ds_read_b128 v[12:15], v48 offset:4096
L_cons_bu:
    s_waitcnt lgkmcnt(3)
    v_mfma_f32_32x32x16_bf16 v[64:79], v[8:11], v[24:27], v[64:79]
    ds_read_b128 v[16:19], v49 offset:0
    ds_read_b128 v[36:39], v53 offset:0
    ds_read_b128 v[40:43], v53 offset:4096
    s_waitcnt lgkmcnt(5)
    v_mfma_f32_32x32x16_bf16 v[80:95], v[8:11], v[28:31], v[80:95]
    ds_read_b128 v[44:47], v53 offset:8192
    ds_read_b128 v[20:23], v49 offset:4096
    s_waitcnt lgkmcnt(6)
    v_mfma_f32_32x32x16_bf16 v[96:111], v[8:11], v[32:35], v[96:111]
    s_waitcnt lgkmcnt(5)
    v_mfma_f32_32x32x16_bf16 v[112:127], v[12:15], v[24:27], v[112:127]
    v_mfma_f32_32x32x16_bf16 v[128:143], v[12:15], v[28:31], v[128:143]
    v_add_u32 v48, s31, v48
    v_add_u32 v52, s31, v52
    v_add_u32 v49, s31, v49
    v_add_u32 v53, s31, v53
    v_mfma_f32_32x32x16_bf16 v[144:159], v[12:15], v[32:35], v[144:159]
    s_waitcnt lgkmcnt(3)
    v_mfma_f32_32x32x16_bf16 v[64:79], v[16:19], v[36:39], v[64:79]
    ds_read_b128 v[8:11], v50 offset:0
    ds_read_b128 v[24:27], v54 offset:0
    ds_read_b128 v[28:31], v54 offset:4096
    s_waitcnt lgkmcnt(5)
    v_mfma_f32_32x32x16_bf16 v[80:95], v[16:19], v[40:43], v[80:95]
    ds_read_b128 v[32:35], v54 offset:8192
    ds_read_b128 v[12:15], v50 offset:4096
    s_waitcnt lgkmcnt(6)
    v_mfma_f32_32x32x16_bf16 v[96:111], v[16:19], v[44:47], v[96:111]
    s_waitcnt lgkmcnt(5)
    v_mfma_f32_32x32x16_bf16 v[112:127], v[20:23], v[36:39], v[112:127]
    v_mfma_f32_32x32x16_bf16 v[128:143], v[20:23], v[40:43], v[128:143]
    v_add_u32 v50, s31, v50
    v_add_u32 v54, s31, v54
    v_mfma_f32_32x32x16_bf16 v[144:159], v[20:23], v[44:47], v[144:159]
    s_cmp_eq_u32 s34, 1
    s_cbranch_scc1 L_nb_bu
    s_barrier
L_nb_bu:
    s_waitcnt lgkmcnt(3)
    v_mfma_f32_32x32x16_bf16 v[64:79], v[8:11], v[24:27], v[64:79]
    ds_read_b128 v[16:19], v51 offset:0
    ds_read_b128 v[36:39], v55 offset:0
    ds_read_b128 v[40:43], v55 offset:4096
    s_waitcnt lgkmcnt(5)
    v_mfma_f32_32x32x16_bf16 v[80:95], v[8:11], v[28:31], v[80:95]
    ds_read_b128 v[44:47], v55 offset:8192
    ds_read_b128 v[20:23], v51 offset:4096
    s_waitcnt lgkmcnt(6)
    v_mfma_f32_32x32x16_bf16 v[96:111], v[8:11], v[32:35], v[96:111]
    s_waitcnt lgkmcnt(5)
    v_mfma_f32_32x32x16_bf16 v[112:127], v[12:15], v[24:27], v[112:127]
    v_mfma_f32_32x32x16_bf16 v[128:143], v[12:15], v[28:31], v[128:143]
    v_add_u32 v51, s31, v51
    v_add_u32 v55, s31, v55
    v_mfma_f32_32x32x16_bf16 v[144:159], v[12:15], v[32:35], v[144:159]
    s_waitcnt lgkmcnt(3)
    v_mfma_f32_32x32x16_bf16 v[64:79], v[16:19], v[36:39], v[64:79]
    ds_read_b128 v[8:11], v48 offset:0
    ds_read_b128 v[24:27], v52 offset:0
    ds_read_b128 v[28:31], v52 offset:4096
    s_waitcnt lgkmcnt(5)
    v_mfma_f32_32x32x16_bf16 v[80:95], v[16:19], v[40:43], v[80:95]
    ds_read_b128 v[32:35], v52 offset:8192
    ds_read_b128 v[12:15], v48 offset:4096
    s_waitcnt lgkmcnt(6)
    v_mfma_f32_32x32x16_bf16 v[96:111], v[16:19], v[44:47], v[96:111]
    s_waitcnt lgkmcnt(5)
    v_mfma_f32_32x32x16_bf16 v[112:127], v[20:23], v[36:39], v[112:127]
    v_mfma_f32_32x32x16_bf16 v[128:143], v[20:23], v[40:43], v[128:143]
    s_add_u32 s30, s30, 1
    s_cmp_eq_u32 s30, 3
    s_cselect_b32 s31, s33, s32
    s_cmp_eq_u32 s30, 4
    s_cselect_b32 s30, 0, s30
    v_mfma_f32_32x32x16_bf16 v[144:159], v[20:23], v[44:47], v[144:159]
    s_sub_u32 s34, s34, 1
    s_cmp_lg_u32 s34, 0
    s_cbranch_scc1 L_cons_bu
    s_waitcnt lgkmcnt(0)
L_k1_epiBU:
    s_nop 7
    s_nop 3
    s_cmp_lg_u32 s61, 0
    s_cbranch_scc1 L_k1_noscBU
    s_mov_b32 s77, s60
    s_mov_b32 s76, s60
    v_pk_mul_f32 v[64:65], v[64:65], s[76:77]
    v_pk_mul_f32 v[66:67], v[66:67], s[76:77]
    v_pk_mul_f32 v[68:69], v[68:69], s[76:77]
    v_pk_mul_f32 v[70:71], v[70:71], s[76:77]
    v_pk_mul_f32 v[72:73], v[72:73], s[76:77]
    v_pk_mul_f32 v[74:75], v[74:75], s[76:77]
    v_pk_mul_f32 v[76:77], v[76:77], s[76:77]
    v_pk_mul_f32 v[78:79], v[78:79], s[76:77]
    v_pk_mul_f32 v[80:81], v[80:81], s[76:77]
    v_pk_mul_f32 v[82:83], v[82:83], s[76:77]
    v_pk_mul_f32 v[84:85], v[84:85], s[76:77]
    v_pk_mul_f32 v[86:87], v[86:87], s[76:77]
    v_pk_mul_f32 v[88:89], v[88:89], s[76:77]
    v_pk_mul_f32 v[90:91], v[90:91], s[76:77]
    v_pk_mul_f32 v[92:93], v[92:93], s[76:77]
    v_pk_mul_f32 v[94:95], v[94:95], s[76:77]
    v_pk_mul_f32 v[96:97], v[96:97], s[76:77]
    v_pk_mul_f32 v[98:99], v[98:99], s[76:77]
    v_pk_mul_f32 v[100:101], v[100:101], s[76:77]
    v_pk_mul_f32 v[102:103], v[102:103], s[76:77]
    v_pk_mul_f32 v[104:105], v[104:105], s[76:77]
    v_pk_mul_f32 v[106:107], v[106:107], s[76:77]
    v_pk_mul_f32 v[108:109], v[108:109], s[76:77]
    v_pk_mul_f32 v[110:111], v[110:111], s[76:77]
    v_pk_mul_f32 v[112:113], v[112:113], s[76:77]
    v_pk_mul_f32 v[114:115], v[114:115], s[76:77]
    v_pk_mul_f32 v[116:117], v[116:117], s[76:77]
    v_pk_mul_f32 v[118:119], v[118:119], s[76:77]
    v_pk_mul_f32 v[120:121], v[120:121], s[76:77]
    v_pk_mul_f32 v[122:123], v[122:123], s[76:77]
    v_pk_mul_f32 v[124:125], v[124:125], s[76:77]
    v_pk_mul_f32 v[126:127], v[126:127], s[76:77]
    v_pk_mul_f32 v[128:129], v[128:129], s[76:77]
    v_pk_mul_f32 v[130:131], v[130:131], s[76:77]
    v_pk_mul_f32 v[132:133], v[132:133], s[76:77]
    v_pk_mul_f32 v[134:135], v[134:135], s[76:77]
    v_pk_mul_f32 v[136:137], v[136:137], s[76:77]
    v_pk_mul_f32 v[138:139], v[138:139], s[76:77]
    v_pk_mul_f32 v[140:141], v[140:141], s[76:77]
    v_pk_mul_f32 v[142:143], v[142:143], s[76:77]
    v_pk_mul_f32 v[144:145], v[144:145], s[76:77]
    v_pk_mul_f32 v[146:147], v[146:147], s[76:77]
    v_pk_mul_f32 v[148:149], v[148:149], s[76:77]
    v_pk_mul_f32 v[150:151], v[150:151], s[76:77]
    v_pk_mul_f32 v[152:153], v[152:153], s[76:77]
    v_pk_mul_f32 v[154:155], v[154:155], s[76:77]
    v_pk_mul_f32 v[156:157], v[156:157], s[76:77]
    v_pk_mul_f32 v[158:159], v[158:159], s[76:77]
L_k1_noscBU:
    v_cvt_pk_bf16_f32 v8, v64, v65
    v_cvt_pk_bf16_f32 v9, v66, v67
    v_cvt_pk_bf16_f32 v10, v68, v69
    v_cvt_pk_bf16_f32 v11, v70, v71
    v_cvt_pk_bf16_f32 v12, v72, v73
    v_cvt_pk_bf16_f32 v13, v74, v75
    v_cvt_pk_bf16_f32 v14, v76, v77
    v_cvt_pk_bf16_f32 v15, v78, v79
    ds_write_b128 v56, v[8:11] offset:0
    ds_write_b128 v57, v[12:15] offset:0
    v_cvt_pk_bf16_f32 v16, v80, v81
    v_cvt_pk_bf16_f32 v17, v82, v83
    v_cvt_pk_bf16_f32 v18, v84, v85
    v_cvt_pk_bf16_f32 v19, v86, v87
    v_cvt_pk_bf16_f32 v20, v88, v89
    v_cvt_pk_bf16_f32 v21, v90, v91
    v_cvt_pk_bf16_f32 v22, v92, v93
    v_cvt_pk_bf16_f32 v23, v94, v95
    ds_write_b128 v56, v[16:19] offset:2048
    ds_write_b128 v57, v[20:23] offset:2048
    s_waitcnt lgkmcnt(2)
    ds_read_b128 v[32:35], v160 offset:0
    ds_read_b128 v[36:39], v161 offset:0
    v_cvt_pk_bf16_f32 v24, v96, v97
    v_cvt_pk_bf16_f32 v25, v98, v99
    v_cvt_pk_bf16_f32 v26, v100, v101
    v_cvt_pk_bf16_f32 v27, v102, v103
    v_cvt_pk_bf16_f32 v28, v104, v105
    v_cvt_pk_bf16_f32 v29, v106, v107
    v_cvt_pk_bf16_f32 v30, v108, v109
    v_cvt_pk_bf16_f32 v31, v110, v111
    ds_write_b128 v56, v[24:27] offset:4096
    ds_write_b128 v57, v[28:31] offset:4096
    s_waitcnt lgkmcnt(4)
    ds_read_b128 v[40:43], v162 offset:2048
    ds_read_b128 v[44:47], v163 offset:2048
    s_waitcnt lgkmcnt(5)
    buffer_store_dwordx4 v[32:35], v166, s[20:23], s69 offen sc1
    s_waitcnt lgkmcnt(4)
    buffer_store_dwordx4 v[36:39], v167, s[20:23], s69 offen sc1
    v_cvt_pk_bf16_f32 v8, v112, v113
    v_cvt_pk_bf16_f32 v9, v114, v115
    v_cvt_pk_bf16_f32 v10, v116, v117
    v_cvt_pk_bf16_f32 v11, v118, v119
    v_cvt_pk_bf16_f32 v12, v120, v121
    v_cvt_pk_bf16_f32 v13, v122, v123
    v_cvt_pk_bf16_f32 v14, v124, v125
    v_cvt_pk_bf16_f32 v15, v126, v127
    ds_write_b128 v56, v[8:11] offset:6144
    ds_write_b128 v57, v[12:15] offset:6144
    s_waitcnt lgkmcnt(4)
    ds_read_b128 v[48:51], v164 offset:4096
    ds_read_b128 v[52:55], v165 offset:4096
    s_waitcnt lgkmcnt(5)
    buffer_store_dwordx4 v[40:43], v168, s[20:23], s69 offen sc1
    s_waitcnt lgkmcnt(4)
    buffer_store_dwordx4 v[44:47], v169, s[20:23], s69 offen sc1
    v_cvt_pk_bf16_f32 v16, v128, v129
    v_cvt_pk_bf16_f32 v17, v130, v131
    v_cvt_pk_bf16_f32 v18, v132, v133
    v_cvt_pk_bf16_f32 v19, v134, v135
    v_cvt_pk_bf16_f32 v20, v136, v137
    v_cvt_pk_bf16_f32 v21, v138, v139
    v_cvt_pk_bf16_f32 v22, v140, v141
    v_cvt_pk_bf16_f32 v23, v142, v143
    ds_write_b128 v56, v[16:19] offset:8192
    ds_write_b128 v57, v[20:23] offset:8192
    s_waitcnt lgkmcnt(4)
    ds_read_b128 v[32:35], v160 offset:6144
    ds_read_b128 v[36:39], v161 offset:6144
    s_waitcnt lgkmcnt(5)
    buffer_store_dwordx4 v[48:51], v170, s[20:23], s69 offen sc1
    s_waitcnt lgkmcnt(4)
    buffer_store_dwordx4 v[52:55], v171, s[20:23], s69 offen sc1
    v_cvt_pk_bf16_f32 v24, v144, v145
    v_cvt_pk_bf16_f32 v25, v146, v147
    v_cvt_pk_bf16_f32 v26, v148, v149
    v_cvt_pk_bf16_f32 v27, v150, v151
    v_cvt_pk_bf16_f32 v28, v152, v153
    v_cvt_pk_bf16_f32 v29, v154, v155
    v_cvt_pk_bf16_f32 v30, v156, v157
    v_cvt_pk_bf16_f32 v31, v158, v159
    ds_write_b128 v56, v[24:27] offset:10240
    ds_write_b128 v57, v[28:31] offset:10240
    s_waitcnt lgkmcnt(4)
    ds_read_b128 v[40:43], v162 offset:8192
    ds_read_b128 v[44:47], v163 offset:8192
    s_waitcnt lgkmcnt(5)
    buffer_store_dwordx4 v[32:35], v166, s[20:23], s70 offen sc1
    s_waitcnt lgkmcnt(4)
    buffer_store_dwordx4 v[36:39], v167, s[20:23], s70 offen sc1
    s_waitcnt lgkmcnt(2)
    ds_read_b128 v[48:51], v164 offset:10240
    ds_read_b128 v[52:55], v165 offset:10240
    s_waitcnt lgkmcnt(3)
    buffer_store_dwordx4 v[40:43], v168, s[20:23], s70 offen sc1
    s_waitcnt lgkmcnt(2)
    buffer_store_dwordx4 v[44:47], v169, s[20:23], s70 offen sc1
    s_waitcnt lgkmcnt(1)
    buffer_store_dwordx4 v[48:51], v170, s[20:23], s70 offen sc1
    s_waitcnt lgkmcnt(0)
    buffer_store_dwordx4 v[52:55], v171, s[20:23], s70 offen sc1
    s_cmp_lg_u32 s61, 2
    s_cbranch_scc1 L_k1_finBU
    v_mov_b32 v24, 0x3f803f80
    v_mov_b32 v25, 0x3f803f80
    v_mov_b32 v26, 0x3f803f80
    v_mov_b32 v27, 0x3f803f80
    s_nop 1
    buffer_store_dwordx4 v[24:27], v172, s[20:23], s69 offen sc1
    buffer_store_dwordx4 v[24:27], v173, s[20:23], s69 offen sc1
    buffer_store_dwordx4 v[24:27], v174, s[20:23], s69 offen sc1
    buffer_store_dwordx4 v[24:27], v175, s[20:23], s69 offen sc1
    buffer_store_dwordx4 v[24:27], v176, s[20:23], s69 offen sc1
    buffer_store_dwordx4 v[24:27], v177, s[20:23], s69 offen sc1
    buffer_store_dwordx4 v[24:27], v172, s[20:23], s70 offen sc1
    buffer_store_dwordx4 v[24:27], v173, s[20:23], s70 offen sc1
    buffer_store_dwordx4 v[24:27], v174, s[20:23], s70 offen sc1
    buffer_store_dwordx4 v[24:27], v175, s[20:23], s70 offen sc1
    buffer_store_dwordx4 v[24:27], v176, s[20:23], s70 offen sc1
    buffer_store_dwordx4 v[24:27], v177, s[20:23], s70 offen sc1
L_k1_finBU:
    s_endpgm
L_k1_prep:
    s_sub_u32 s35, s35, 16
    s_cmp_lg_u32 s3, 0
    s_cbranch_scc1 L_prep_nocpf
    s_getpc_b64 s[76:77]
L_cpf_k1b:
    s_add_u32 s76, s76, s5mha_k2_kernel-L_cpf_k1b
    s_addc_u32 s77, s77, ((s5mha_k2_kernel-L_cpf_k1b)>>32)
    v_lshlrev_b32 v62, 7, v2
    v_min_u32 v62, L_k2_codeend-s5mha_k2_kernel-4, v62
    global_load_dword v63, v62, s[76:77]
    v_lshlrev_b32 v62, 7, v2
    v_add_u32 v62, 8192, v62
    v_min_u32 v62, L_k2_codeend-s5mha_k2_kernel-4, v62
    global_load_dword v63, v62, s[76:77]
    s_getpc_b64 s[76:77]
L_cpf_k1c:
    s_add_u32 s76, s76, s5mha_k3_kernel-L_cpf_k1c
    s_addc_u32 s77, s77, ((s5mha_k3_kernel-L_cpf_k1c)>>32)
    v_lshlrev_b32 v62, 7, v2
    v_min_u32 v62, L_k3_codeend-s5mha_k3_kernel-4, v62
    global_load_dword v63, v62, s[76:77]
    v_lshlrev_b32 v62, 7, v2
    v_add_u32 v62, 8192, v62
    v_min_u32 v62, L_k3_codeend-s5mha_k3_kernel-4, v62
    global_load_dword v63, v62, s[76:77]
L_prep_nocpf:
    s_waitcnt lgkmcnt(0)
    s_load_dwordx4 s[44:47], s[0:1], 8
    s_load_dwordx2 s[52:53], s[0:1], 56
    s_lshl_b32 s63, s35, 3
    s_add_u32 s63, s63, s3
    v_lshlrev_b32 v10, 7, v2
    v_add_u32 v10, s63, v10
    v_lshlrev_b32 v12, 1, v10
    s_waitcnt lgkmcnt(0)
    s_mov_b32 s8, s44
    s_and_b32 s9, s45, 0xffff
    s_mov_b32 s10, 1152
    s_mov_b32 s11, 0x20000
    s_mov_b32 s12, s46
    s_and_b32 s13, s47, 0xffff
    s_mov_b32 s14, 1152
    s_mov_b32 s15, 0x20000
    s_mov_b32 s16, s52
    s_and_b32 s17, s53, 0xffff
    s_mov_b32 s18, 1152
    s_mov_b32 s19, 0x20000
    s_mov_b32 s20, s40
    s_and_b32 s21, s41, 0xffff
    s_mov_b32 s22, 16586240
    s_mov_b32 s23, 0x20000
    buffer_load_ushort v44, v12, s[8:11], 0 offen
    buffer_load_ushort v45, v12, s[12:15], 0 offen
    buffer_load_ushort v46, v12, s[16:19], 0 offen
    v_add_u32 v14, 1, v2
    v_lshlrev_b32 v14, 5, v14
    v_cvt_f32_u32 v14, v14
    v_lshlrev_b32 v15, 3, v2
    s_waitcnt vmcnt(0)
    v_lshlrev_b32 v44, 16, v44
    v_lshlrev_b32 v45, 16, v45
    v_lshlrev_b32 v46, 16, v46
    v_mul_f32 v46, 0x3fb8aa3b, v46
    v_exp_f32 v46, v46
    s_nop 0
    v_cvt_pk_bf16_f32 v46, v46, v46
    v_lshlrev_b32 v46, 16, v46
    v_mul_f32 v51, v46, v45
    v_mul_f32 v50, v46, v44
    v_mul_f32 v51, 0x3e22f983, v51
    v_mul_f32 v50, 0x3fb8aa3b, v50
    v_exp_f32 v52, v50
    v_fract_f32 v53, v51
    s_nop 0
    v_cos_f32 v54, v53
    v_sin_f32 v55, v53
    s_nop 0
    v_mul_f32 v54, v54, v52
    v_mul_f32 v55, v55, v52
    v_add_f32 v58, -1.0, v54
    v_mul_f32 v56, v44, v44
    v_fmac_f32 v56, v45, v45
    v_rcp_f32 v56, v56
    v_mul_f32 v57, v58, v44
    v_fmac_f32 v57, v55, v45
    v_mul_f32 v59, v55, v44
    v_mul_f32 v60, v58, v45
    v_sub_f32 v59, v59, v60
    v_add_f32 v56, v56, v56
    v_mul_f32 v60, v57, v56
    v_mul_f32 v61, v59, v56
    v_lshlrev_b32 v16, 3, v10
    v_mul_u32_u24 v17, 528, v10
    v_cmp_gt_u32 vcc, 576, v10
    v_mov_b32 v18, 0x7f000000
    v_mov_b32 v62, 1.0
    v_cndmask_b32 v16, v18, v16, vcc
    v_cndmask_b32 v17, v18, v17, vcc
    v_mov_b32 v63, 0
    s_mov_b32 s64, 16581632
    s_mov_b32 s65, 16277504
    buffer_store_dwordx2 v[60:61], v16, s[20:23], s64 offen sc1
    buffer_store_dwordx2 v[62:63], v17, s[20:23], s65 offen sc1
    buffer_store_dwordx2 v[54:55], v17, s[20:23], s65 offen offset:520 sc1
    s_add_u32 s64, s63, 0
    v_readlane_b32 s66, v50, 0
    v_readlane_b32 s67, v51, 0
    s_mul_i32 s68, s64, 528
    s_add_u32 s68, s68, 16277504
    v_mul_f32 v66, s66, v14
    v_mul_f32 v67, s67, v14
    v_exp_f32 v66, v66
    v_fract_f32 v67, v67
    s_nop 0
    v_cos_f32 v64, v67
    v_sin_f32 v65, v67
    s_nop 0
    v_mul_f32 v64, v64, v66
    v_mul_f32 v65, v65, v66
    buffer_store_dwordx2 v[64:65], v15, s[20:23], s68 offen offset:8 sc1
    s_add_u32 s64, s63, 128
    v_readlane_b32 s66, v50, 1
    v_readlane_b32 s67, v51, 1
    s_mul_i32 s68, s64, 528
    s_add_u32 s68, s68, 16277504
    v_mul_f32 v70, s66, v14
    v_mul_f32 v71, s67, v14
    v_exp_f32 v70, v70
    v_fract_f32 v71, v71
    s_nop 0
    v_cos_f32 v68, v71
    v_sin_f32 v69, v71
    s_nop 0
    v_mul_f32 v68, v68, v70
    v_mul_f32 v69, v69, v70
    buffer_store_dwordx2 v[68:69], v15, s[20:23], s68 offen offset:8 sc1
    s_add_u32 s64, s63, 256
    v_readlane_b32 s66, v50, 2
    v_readlane_b32 s67, v51, 2
    s_mul_i32 s68, s64, 528
    s_add_u32 s68, s68, 16277504
    v_mul_f32 v74, s66, v14
    v_mul_f32 v75, s67, v14
    v_exp_f32 v74, v74
    v_fract_f32 v75, v75
    s_nop 0
    v_cos_f32 v72, v75
    v_sin_f32 v73, v75
    s_nop 0
    v_mul_f32 v72, v72, v74
    v_mul_f32 v73, v73, v74
    buffer_store_dwordx2 v[72:73], v15, s[20:23], s68 offen offset:8 sc1
    s_add_u32 s64, s63, 384
    v_readlane_b32 s66, v50, 3
    v_readlane_b32 s67, v51, 3
    s_mul_i32 s68, s64, 528
    s_add_u32 s68, s68, 16277504
    v_mul_f32 v78, s66, v14
    v_mul_f32 v79, s67, v14
    v_exp_f32 v78, v78
    v_fract_f32 v79, v79
    s_nop 0
    v_cos_f32 v76, v79
    v_sin_f32 v77, v79
    s_nop 0
    v_mul_f32 v76, v76, v78
    v_mul_f32 v77, v77, v78
    buffer_store_dwordx2 v[76:77], v15, s[20:23], s68 offen offset:8 sc1
    s_add_u32 s64, s63, 512
    s_cmp_ge_u32 s64, 576
    s_cbranch_scc1 L_prep_done
    v_readlane_b32 s66, v50, 4
    v_readlane_b32 s67, v51, 4
    s_mul_i32 s68, s64, 528
    s_add_u32 s68, s68, 16277504
    v_mul_f32 v82, s66, v14
    v_mul_f32 v83, s67, v14
    v_exp_f32 v82, v82
    v_fract_f32 v83, v83
    s_nop 0
    v_cos_f32 v80, v83
    v_sin_f32 v81, v83
    s_nop 0
    v_mul_f32 v80, v80, v82
    v_mul_f32 v81, v81, v82
    buffer_store_dwordx2 v[80:81], v15, s[20:23], s68 offen offset:8 sc1
L_prep_done:
L_k1_end:
    s_endpgm
L_k1_codeend:
.section .rodata,"a"
.p2align 6
.amdhsa_kernel s5mha_k1_kernel
  .amdhsa_next_free_vgpr 202
  .amdhsa_next_free_sgpr 96
  .amdhsa_accum_offset 204
  .amdhsa_group_segment_fixed_size 0
  .amdhsa_kernarg_size 120
  .amdhsa_user_sgpr_count 2
  .amdhsa_user_sgpr_kernarg_segment_ptr 1
  .amdhsa_system_sgpr_workgroup_id_x 1
  .amdhsa_float_denorm_mode_32 3
.end_amdhsa_kernel

.text
.globl s5mha_k2_kernel
.p2align 8
.type s5mha_k2_kernel,@function
s5mha_k2_kernel:

    s_cmp_ge_u32 s2, 256
    s_cbranch_scc1 L_k2_end
    s_load_dwordx2 s[40:41], s[0:1], 112
    v_lshrrev_b32 v1, 6, v0
    v_and_b32 v2, 63, v0
    s_and_b32 s4, s2, 31
    v_readfirstlane_b32 s3, v1
    s_lshr_b32 s5, s2, 5
    v_lshlrev_b32 v7, 4, v2
    v_mov_b32 v3, 0
    v_mov_b32 v4, 160768
    v_mov_b32 v5, 0
    v_mov_b32 v6, 0
    ds_write_b32 v4, v3
    v_mov_b32 v8, 0
    v_mov_b32 v9, 0
    ds_write_b64 v4, v[8:9] offset:8
    s_mul_i32 s11, s4, 73728
    s_mul_i32 s12, s4, 77824
    s_add_u32 s13, s11, 2359296
    s_add_u32 s14, s12, 4718592
    s_mul_i32 s15, s5, 9216
    s_add_u32 s15, s15, s11
    s_cmp_lt_u32 s2, 144
    s_cselect_b32 s8, 1, 0
    s_cmp_lt_u32 s3, 4
    s_cselect_b32 s8, s8, 0
    s_cmp_ge_u32 s2, 144
    s_cselect_b32 s9, 1, 0
    s_cmp_lt_u32 s3, 4
    s_cselect_b32 s9, s9, 0
    s_mov_b32 s6, 0
    s_cmp_lg_u32 s3, 15
    s_cbranch_scc1 L_k2_nocpf
    s_getpc_b64 s[76:77]
L_cpf_k2:
    s_add_u32 s76, s76, s5mha_k2_kernel-L_cpf_k2
    s_addc_u32 s77, s77, ((s5mha_k2_kernel-L_cpf_k2)>>32)
    v_lshlrev_b32 v0, 7, v2
    v_min_u32 v0, L_k2_codeend-s5mha_k2_kernel-4, v0
    global_load_dword v1, v0, s[76:77]
    v_lshlrev_b32 v0, 7, v2
    v_add_u32 v0, 8192, v0
    v_min_u32 v0, L_k2_codeend-s5mha_k2_kernel-4, v0
    global_load_dword v1, v0, s[76:77]
L_k2_nocpf:
    s_waitcnt lgkmcnt(0)
    s_mov_b32 s20, s40
    s_and_b32 s21, s41, 0xffff
    s_mov_b32 s22, 16586240
    s_mov_b32 s23, 0x20000
L_k2_dma:
    s_lshr_b32 s16, s3, 2
    s_and_b32 s17, s3, 3
    s_min_u32 s18, s3, 8
    s_lshl_b32 s18, s18, 10
    s_add_u32 s19, s18, s15
    s_add_u32 m0, s18, 151552
    s_and_b32 s24, s16, 1
    buffer_load_dwordx4 v7, s[20:23], s19 offen lds
    s_mul_i32 s25, s24, 36864
    s_mul_i32 s26, s24, 38912
    s_cmp_ge_u32 s16, 2
    s_cselect_b32 s25, s26, s25
    s_cselect_b32 s26, s14, s13
    s_cselect_b32 s27, 73728, 0
    s_cselect_b32 s36, 37, 35
    s_add_u32 s26, s26, s25
    s_add_u32 s27, s27, s25
    s_add_u32 s18, s17, 0
    s_lshl_b32 s18, s18, 10
    s_add_u32 m0, s27, s18
    s_add_u32 s19, s26, s18
    buffer_load_dwordx4 v7, s[20:23], s19 offen lds
    s_add_u32 s18, s17, 4
    s_lshl_b32 s18, s18, 10
    s_add_u32 m0, s27, s18
    s_add_u32 s19, s26, s18
    buffer_load_dwordx4 v7, s[20:23], s19 offen lds
    s_and_b32 s24, s3, 7
    s_lshr_b32 s25, s3, 3
    v_lshrrev_b32 v4, 4, v2
    v_bfe_u32 v5, v2, 2, 2
    v_and_b32 v6, 3, v2
    v_lshrrev_b32 v8, 1, v4
    v_and_b32 v4, 1, v4
    v_lshl_add_u32 v9, v8, 3, v5
    v_lshlrev_b32 v9, 6, v9
    v_lshlrev_b32 v10, 5, v4
    v_lshl_add_u32 v10, v6, 3, v10
    s_mul_i32 s28, s24, 1152
    s_add_u32 s28, s28, 151552
    v_add3_u32 v124, v9, v10, s28
    v_and_b32 v12, 1, v5
    v_add_u32 v12, 16, v12
    v_lshlrev_b32 v12, 6, v12
    v_add3_u32 v125, v12, v10, s28
    v_and_b32 v14, 1, v6
    v_lshlrev_b32 v14, 1, v14
    v_lshrrev_b32 v15, 1, v6
    v_or_b32 v14, v14, v15
    v_lshlrev_b32 v15, 5, v4
    v_lshl_add_u32 v15, v14, 3, v15
    s_mul_i32 s30, s25, 36864
    v_add3_u32 v120, v9, v15, s30
    v_add3_u32 v121, v12, v15, s30
    v_lshrrev_b32 v16, 1, v5
    v_or_b32 v16, v16, v8
    v_cmp_eq_u32 vcc, 0, v16
    v_mov_b32 v17, 0x30000
    s_nop 0
    v_cndmask_b32 v121, v17, v121, vcc
    v_and_b32 v14, 31, v2
    v_lshrrev_b32 v15, 5, v2
    v_subrev_u32 v16, 16, v14
    v_cmp_gt_u32 vcc, 19, v14
    s_mul_i32 s28, s25, 38912
    s_add_u32 s28, s28, 73728
    v_cndmask_b32 v14, v16, v14, vcc
    v_bfe_u32 v16, v14, 2, 2
    v_lshlrev_b32 v14, 6, v14
    v_xor_b32 v17, v15, v16
    v_lshl_add_u32 v17, v17, 4, v14
    v_add_u32 v122, s28, v17
    v_add_u32 v15, 2, v15
    v_xor_b32 v17, v15, v16
    v_lshl_add_u32 v17, v17, 4, v14
    v_add_u32 v123, s28, v17
    v_and_b32 v14, 31, v2
    v_cmp_gt_u32 vcc, 19, v14
    v_mov_b32 v15, 0x30000
    s_nop 0
    v_cndmask_b32 v122, v15, v122, vcc
    v_cndmask_b32 v123, v15, v123, vcc
    s_waitcnt vmcnt(0)
    s_barrier
    s_cmp_lt_u32 s3, 4
    s_cselect_b32 s10, 1, 0
    s_cbranch_scc0 L_k2_att0
    s_setprio 3
    s_and_b32 s24, s3, 1
    s_mul_i32 s25, s24, 36864
    s_mul_i32 s26, s24, 38912
    s_cmp_ge_u32 s3, 2
    s_cselect_b32 s25, s26, s25
    s_cselect_b32 s26, s14, s13
    s_cselect_b32 s27, 73728, 0
    s_cselect_b32 s36, 37, 35
    s_add_u32 s26, s26, s25
    s_add_u32 s27, s27, s25
    s_add_u32 m0, s27, 8192
    s_add_u32 s19, s26, 8192
    buffer_load_dwordx4 v7, s[20:23], s19 offen lds
    s_add_u32 m0, s27, 9216
    s_add_u32 s19, s26, 9216
    buffer_load_dwordx4 v7, s[20:23], s19 offen lds
    s_add_u32 m0, s27, 10240
    s_add_u32 s19, s26, 10240
    buffer_load_dwordx4 v7, s[20:23], s19 offen lds
    s_add_u32 m0, s27, 11264
    s_add_u32 s19, s26, 11264
    buffer_load_dwordx4 v7, s[20:23], s19 offen lds
    s_add_u32 m0, s27, 12288
    s_add_u32 s19, s26, 12288
    buffer_load_dwordx4 v7, s[20:23], s19 offen lds
    s_add_u32 m0, s27, 13312
    s_add_u32 s19, s26, 13312
    buffer_load_dwordx4 v7, s[20:23], s19 offen lds
    s_add_u32 m0, s27, 14336
    s_add_u32 s19, s26, 14336
    buffer_load_dwordx4 v7, s[20:23], s19 offen lds
    s_add_u32 m0, s27, 15360
    s_add_u32 s19, s26, 15360
    buffer_load_dwordx4 v7, s[20:23], s19 offen lds
    s_add_u32 m0, s27, 16384
    s_add_u32 s19, s26, 16384
    buffer_load_dwordx4 v7, s[20:23], s19 offen lds
    s_add_u32 m0, s27, 17408
    s_add_u32 s19, s26, 17408
    buffer_load_dwordx4 v7, s[20:23], s19 offen lds
    s_add_u32 m0, s27, 18432
    s_add_u32 s19, s26, 18432
    buffer_load_dwordx4 v7, s[20:23], s19 offen lds
    s_add_u32 m0, s27, 19456
    s_add_u32 s19, s26, 19456
    buffer_load_dwordx4 v7, s[20:23], s19 offen lds
    s_cmp_eq_u32 s6, 0
    s_cbranch_scc1 L_k2_att0
    s_add_u32 m0, s27, 20480
    s_add_u32 s19, s26, 20480
    buffer_load_dwordx4 v7, s[20:23], s19 offen lds
    s_add_u32 m0, s27, 21504
    s_add_u32 s19, s26, 21504
    buffer_load_dwordx4 v7, s[20:23], s19 offen lds
    s_add_u32 m0, s27, 22528
    s_add_u32 s19, s26, 22528
    buffer_load_dwordx4 v7, s[20:23], s19 offen lds
    s_add_u32 m0, s27, 23552
    s_add_u32 s19, s26, 23552
    buffer_load_dwordx4 v7, s[20:23], s19 offen lds
    s_add_u32 m0, s27, 24576
    s_add_u32 s19, s26, 24576
    buffer_load_dwordx4 v7, s[20:23], s19 offen lds
    s_add_u32 m0, s27, 25600
    s_add_u32 s19, s26, 25600
    buffer_load_dwordx4 v7, s[20:23], s19 offen lds
    s_add_u32 m0, s27, 26624
    s_add_u32 s19, s26, 26624
    buffer_load_dwordx4 v7, s[20:23], s19 offen lds
    s_add_u32 m0, s27, 27648
    s_add_u32 s19, s26, 27648
    buffer_load_dwordx4 v7, s[20:23], s19 offen lds
    s_add_u32 m0, s27, 28672
    s_add_u32 s19, s26, 28672
    buffer_load_dwordx4 v7, s[20:23], s19 offen lds
    s_add_u32 m0, s27, 29696
    s_add_u32 s19, s26, 29696
    buffer_load_dwordx4 v7, s[20:23], s19 offen lds
    s_add_u32 m0, s27, 30720
    s_add_u32 s19, s26, 30720
    buffer_load_dwordx4 v7, s[20:23], s19 offen lds
    s_add_u32 m0, s27, 31744
    s_add_u32 s19, s26, 31744
    buffer_load_dwordx4 v7, s[20:23], s19 offen lds
    s_add_u32 m0, s27, 32768
    s_add_u32 s19, s26, 32768
    buffer_load_dwordx4 v7, s[20:23], s19 offen lds
    s_add_u32 m0, s27, 33792
    s_add_u32 s19, s26, 33792
    buffer_load_dwordx4 v7, s[20:23], s19 offen lds
    s_add_u32 m0, s27, 34816
    s_add_u32 s19, s26, 34816
    buffer_load_dwordx4 v7, s[20:23], s19 offen lds
    s_add_u32 m0, s27, 35840
    s_add_u32 s19, s26, 35840
    buffer_load_dwordx4 v7, s[20:23], s19 offen lds
    s_min_u32 s18, s36, 36
    s_lshl_b32 s18, s18, 10
    s_add_u32 m0, s27, s18
    s_add_u32 s19, s26, s18
    buffer_load_dwordx4 v7, s[20:23], s19 offen lds
    s_min_u32 s18, s36, 37
    s_lshl_b32 s18, s18, 10
    s_add_u32 m0, s27, s18
    s_add_u32 s19, s26, s18
    buffer_load_dwordx4 v7, s[20:23], s19 offen lds
    s_mov_b32 s10, 0
    s_waitcnt vmcnt(0)
    v_mov_b32 v4, 160776
    v_mov_b32 v5, 1
    v_cmp_eq_u32 vcc, 0, v2
    s_and_saveexec_b64 s[34:35], vcc
    ds_add_u32 v4, v5
    ds_add_u32 v4, v5 offset:4
    s_mov_b64 exec, s[34:35]
L_k2_att0:
L_k2_att:
    s_and_b32 s24, s3, 7
    s_lshr_b32 s25, s3, 3
    ds_read_b64_tr_b16 v[8:9], v124
    ds_read_b64_tr_b16 v[10:11], v124 offset:256
    ds_read_b64_tr_b16 v[12:13], v125
    s_mov_b32 s74, 0x7ffff
    s_mov_b32 s75, 0x7ffff
    v_mov_b32 v104, 0
    v_mov_b32 v105, 0
    v_mov_b32 v106, 0
    v_mov_b32 v107, 0
    v_mov_b32 v108, 0
    v_mov_b32 v109, 0
    v_mov_b32 v110, 0
    v_mov_b32 v111, 0
    ds_read_b64_tr_b16 v[88:89], v120 offset:0
    ds_read_b64_tr_b16 v[90:91], v120 offset:256
    ds_read_b64_tr_b16 v[92:93], v121 offset:0
    ds_read_b64_tr_b16 v[96:97], v120 offset:1152
    ds_read_b64_tr_b16 v[98:99], v120 offset:1408
    ds_read_b64_tr_b16 v[100:101], v121 offset:1152
    ds_read_b128 v[104:107], v122 offset:0
    ds_read_b128 v[108:111], v123 offset:0
    v_mov_b32 v94, 0
    v_mov_b32 v95, 0
    v_mov_b32 v102, 0
    v_mov_b32 v103, 0
    v_mov_b32 v16, 0
    v_mov_b32 v17, 0
    v_mov_b32 v18, 0
    v_mov_b32 v19, 0
    v_mov_b32 v20, 0
    v_mov_b32 v21, 0
    v_mov_b32 v22, 0
    v_mov_b32 v23, 0
    v_mov_b32 v24, 0
    v_mov_b32 v25, 0
    v_mov_b32 v26, 0
    v_mov_b32 v27, 0
    v_mov_b32 v28, 0
    v_mov_b32 v29, 0
    v_mov_b32 v30, 0
    v_mov_b32 v31, 0
    v_mov_b32 v40, 0
    v_mov_b32 v41, 0
    v_mov_b32 v42, 0
    v_mov_b32 v43, 0
    v_mov_b32 v44, 0
    v_mov_b32 v45, 0
    v_mov_b32 v46, 0
    v_mov_b32 v47, 0
    v_mov_b32 v48, 0
    v_mov_b32 v49, 0
    v_mov_b32 v50, 0
    v_mov_b32 v51, 0
    v_mov_b32 v52, 0
    v_mov_b32 v53, 0
    v_mov_b32 v54, 0
    v_mov_b32 v55, 0
    v_mov_b32 v32, 0
    v_mov_b32 v112, 0
    v_mov_b32 v33, 0
    v_mov_b32 v113, 0
    v_mov_b32 v34, 0
    v_mov_b32 v114, 0
    v_mov_b32 v35, 0
    v_mov_b32 v115, 0
    v_mov_b32 v36, 0
    v_mov_b32 v116, 0
    v_mov_b32 v37, 0
    v_mov_b32 v117, 0
    v_mov_b32 v38, 0
    v_mov_b32 v118, 0
    v_mov_b32 v39, 0
    v_mov_b32 v119, 0
    v_mov_b32 v14, 0
    v_mov_b32 v15, 0
    v_cmp_gt_u32 vcc, 32, v2
    s_waitcnt lgkmcnt(0)
    v_mov_b32 v13, 0
    v_cndmask_b32 v12, 0, v12, vcc
    s_cmp_eq_u32 s6, 0
    s_cbranch_scc1 L_k2_go
    s_lshl_b32 s37, s6, 2
    s_add_u32 s37, s37, 4
    v_mov_b32 v4, 160780
L_k2_pollpre:
    ds_read_b32 v5, v4
    s_waitcnt lgkmcnt(0)
    v_readfirstlane_b32 s38, v5
    s_nop 3
    s_cmp_ge_u32 s38, s37
    s_cbranch_scc0 L_k2_pollpre
    s_mul_i32 s30, s25, 36864
    v_subrev_u32 v126, s30, v120
    v_subrev_u32 v127, s30, v121
    v_mov_b32 v3, 0xff800000
    s_mov_b32 s29, 64
L_k2_pre:
    ds_read_b64_tr_b16 v[88:89], v126 offset:0
    ds_read_b64_tr_b16 v[90:91], v126 offset:256
    ds_read_b64_tr_b16 v[92:93], v127 offset:0
    v_add_u32 v126, 1152, v126
    v_add_u32 v127, 1152, v127
    s_waitcnt lgkmcnt(0)
    v_mfma_f32_32x32x16_bf16 v[56:71], v[88:91], v[8:11], 0
    v_mfma_f32_32x32x16_bf16 v[56:71], v[92:95], v[12:15], v[56:71]
    s_nop 7
    s_nop 7
    v_max3_f32 v3, v3, v56, v57
    v_max3_f32 v3, v3, v58, v59
    v_max3_f32 v3, v3, v60, v61
    v_max3_f32 v3, v3, v62, v63
    v_max3_f32 v3, v3, v64, v65
    v_max3_f32 v3, v3, v66, v67
    v_max3_f32 v3, v3, v68, v69
    v_max3_f32 v3, v3, v70, v71
    s_sub_u32 s29, s29, 1
    s_cmp_lg_u32 s29, 0
    s_cbranch_scc1 L_k2_pre
    v_mov_b32 v4, v3
    v_mov_b32 v5, v3
    s_nop 1
    v_permlane32_swap_b32 v4, v5
    s_nop 1
    v_max_f32 v3, v3, v4
    v_max_f32 v3, v3, v5
    v_sub_f32 v16, 0, v3
    v_sub_f32 v17, 0, v3
    v_sub_f32 v18, 0, v3
    v_sub_f32 v19, 0, v3
    v_sub_f32 v20, 0, v3
    v_sub_f32 v21, 0, v3
    v_sub_f32 v22, 0, v3
    v_sub_f32 v23, 0, v3
    v_sub_f32 v24, 0, v3
    v_sub_f32 v25, 0, v3
    v_sub_f32 v26, 0, v3
    v_sub_f32 v27, 0, v3
    v_sub_f32 v28, 0, v3
    v_sub_f32 v29, 0, v3
    v_sub_f32 v30, 0, v3
    v_sub_f32 v31, 0, v3
    ds_read_b64_tr_b16 v[88:89], v120 offset:0
    ds_read_b64_tr_b16 v[90:91], v120 offset:256
    ds_read_b64_tr_b16 v[92:93], v121 offset:0
    s_waitcnt lgkmcnt(0)
L_k2_go:
    s_nop 1
    v_mfma_f32_32x32x16_bf16 v[56:71], v[88:91], v[8:11], v[16:31]
    v_mfma_f32_32x32x16_bf16 v[56:71], v[92:95], v[12:15], v[56:71]
    s_mov_b32 s29, 0
    s_nop 7
    s_cmp_lt_u32 s3, 4
    s_cbranch_scc1 L_k2_pra
    s_setprio 2
    s_branch L_k2_pqa
L_k2_pra:
    s_setprio 3
L_k2_pqa:
    s_mov_b32 s29, 0
L_k2_loop:
    s_cmp_eq_u32 s29, 1
    s_cbranch_scc0 L_k2_noC
    s_cmp_eq_u32 s10, 0
    s_cbranch_scc1 L_k2_noC
    s_waitcnt vmcnt(0)
    v_mov_b32 v4, 160780
    v_mov_b32 v5, 1
    v_cmp_eq_u32 vcc, 0, v2
    s_and_saveexec_b64 s[34:35], vcc
    ds_add_u32 v4, v5
    s_mov_b64 exec, s[34:35]
    s_mov_b32 s10, 0
L_k2_noC:
    s_cmp_eq_u32 s29, 3
    s_cbranch_scc0 L_k2_np1
    s_cmp_lt_u32 s3, 4
    s_cbranch_scc1 L_k2_prc
    s_setprio 0
    s_branch L_k2_pqc
L_k2_prc:
    s_setprio 1
L_k2_pqc:
L_k2_np1:
    ds_read_b64_tr_b16 v[88:89], v120 offset:2304
    ds_read_b64_tr_b16 v[90:91], v120 offset:2560
    ds_read_b64_tr_b16 v[92:93], v121 offset:2304
    v_mfma_f32_32x32x16_bf16 v[40:55], v[116:119], v[36:39], v[40:55]
    ds_read_b128 v[112:115], v122 offset:1216
    ds_read_b128 v[116:119], v123 offset:1216
    v_exp_f32 v56, v56
    v_exp_f32 v57, v57
    v_exp_f32 v58, v58
    s_waitcnt lgkmcnt(5)
    v_mfma_f32_32x32x16_bf16 v[72:87], v[96:99], v[8:11], v[16:31]
    v_exp_f32 v59, v59
    v_exp_f32 v60, v60
    v_exp_f32 v61, v61
    v_cvt_pk_bf16_f32 v32, v56, v57
    v_exp_f32 v62, v62
    v_exp_f32 v63, v63
    v_cvt_pk_bf16_f32 v33, v58, v59
    v_mfma_f32_32x32x16_bf16 v[72:87], v[100:103], v[12:15], v[72:87]
    v_exp_f32 v64, v64
    v_exp_f32 v65, v65
    v_cvt_pk_bf16_f32 v34, v60, v61
    v_exp_f32 v66, v66
    v_exp_f32 v67, v67
    v_cvt_pk_bf16_f32 v35, v62, v63
    v_exp_f32 v68, v68
    v_exp_f32 v69, v69
    v_mfma_f32_32x32x16_bf16 v[40:55], v[104:107], v[32:35], v[40:55]
    v_cvt_pk_bf16_f32 v36, v64, v65
    v_exp_f32 v70, v70
    v_exp_f32 v71, v71
    v_cvt_pk_bf16_f32 v37, v66, v67
    s_nop 0
    v_cvt_pk_bf16_f32 v38, v68, v69
    v_cvt_pk_bf16_f32 v39, v70, v71
    ds_read_b64_tr_b16 v[96:97], v120 offset:3456
    ds_read_b64_tr_b16 v[98:99], v120 offset:3712
    ds_read_b64_tr_b16 v[100:101], v121 offset:3456
    v_mfma_f32_32x32x16_bf16 v[40:55], v[108:111], v[36:39], v[40:55]
    ds_read_b128 v[104:107], v122 offset:2432
    ds_read_b128 v[108:111], v123 offset:2432
    v_exp_f32 v72, v72
    v_exp_f32 v73, v73
    v_exp_f32 v74, v74
    s_waitcnt lgkmcnt(5)
    v_mfma_f32_32x32x16_bf16 v[56:71], v[88:91], v[8:11], v[16:31]
    v_exp_f32 v75, v75
    v_exp_f32 v76, v76
    v_exp_f32 v77, v77
    v_cvt_pk_bf16_f32 v32, v72, v73
    v_exp_f32 v78, v78
    v_exp_f32 v79, v79
    v_cvt_pk_bf16_f32 v33, v74, v75
    v_mfma_f32_32x32x16_bf16 v[56:71], v[92:95], v[12:15], v[56:71]
    v_exp_f32 v80, v80
    v_exp_f32 v81, v81
    v_cvt_pk_bf16_f32 v34, v76, v77
    v_exp_f32 v82, v82
    v_exp_f32 v83, v83
    v_cvt_pk_bf16_f32 v35, v78, v79
    v_exp_f32 v84, v84
    v_exp_f32 v85, v85
    v_mfma_f32_32x32x16_bf16 v[40:55], v[112:115], v[32:35], v[40:55]
    v_cvt_pk_bf16_f32 v36, v80, v81
    v_exp_f32 v86, v86
    v_exp_f32 v87, v87
    v_cvt_pk_bf16_f32 v37, v82, v83
    s_nop 0
    v_cvt_pk_bf16_f32 v38, v84, v85
    v_cvt_pk_bf16_f32 v39, v86, v87
    s_cmp_eq_u32 s10, 0
    s_cbranch_scc1 L_k2_pB
    s_waitcnt vmcnt(0)
    v_mov_b32 v4, 160776
    v_mov_b32 v5, 1
    v_cmp_eq_u32 vcc, 0, v2
    s_and_saveexec_b64 s[34:35], vcc
    ds_add_u32 v4, v5
    s_mov_b64 exec, s[34:35]
L_k2_pB:
    ds_read_b64_tr_b16 v[88:89], v120 offset:4608
    ds_read_b64_tr_b16 v[90:91], v120 offset:4864
    ds_read_b64_tr_b16 v[92:93], v121 offset:4608
    v_mfma_f32_32x32x16_bf16 v[40:55], v[116:119], v[36:39], v[40:55]
    ds_read_b128 v[112:115], v122 offset:3648
    ds_read_b128 v[116:119], v123 offset:3648
    s_cmp_eq_u32 s10, 0
    s_cbranch_scc1 L_k2_nd1
    s_add_u32 m0, s27, 20480
    s_add_u32 s19, s26, 20480
    buffer_load_dwordx4 v7, s[20:23], s19 offen lds
    s_add_u32 m0, s27, 21504
    s_add_u32 s19, s26, 21504
    buffer_load_dwordx4 v7, s[20:23], s19 offen lds
    s_add_u32 m0, s27, 22528
    s_add_u32 s19, s26, 22528
    buffer_load_dwordx4 v7, s[20:23], s19 offen lds
L_k2_nd1:
    v_exp_f32 v56, v56
    v_exp_f32 v57, v57
    v_exp_f32 v58, v58
    s_waitcnt lgkmcnt(5)
    v_mfma_f32_32x32x16_bf16 v[72:87], v[96:99], v[8:11], v[16:31]
    v_exp_f32 v59, v59
    v_exp_f32 v60, v60
    v_exp_f32 v61, v61
    v_cvt_pk_bf16_f32 v32, v56, v57
    v_exp_f32 v62, v62
    v_exp_f32 v63, v63
    v_cvt_pk_bf16_f32 v33, v58, v59
    v_mfma_f32_32x32x16_bf16 v[72:87], v[100:103], v[12:15], v[72:87]
    v_exp_f32 v64, v64
    v_exp_f32 v65, v65
    v_cvt_pk_bf16_f32 v34, v60, v61
    v_exp_f32 v66, v66
    v_exp_f32 v67, v67
    v_cvt_pk_bf16_f32 v35, v62, v63
    v_exp_f32 v68, v68
    v_exp_f32 v69, v69
    v_mfma_f32_32x32x16_bf16 v[40:55], v[104:107], v[32:35], v[40:55]
    v_cvt_pk_bf16_f32 v36, v64, v65
    v_exp_f32 v70, v70
    v_exp_f32 v71, v71
    v_cvt_pk_bf16_f32 v37, v66, v67
    s_nop 0
    v_cvt_pk_bf16_f32 v38, v68, v69
    v_cvt_pk_bf16_f32 v39, v70, v71
    ds_read_b64_tr_b16 v[96:97], v120 offset:5760
    ds_read_b64_tr_b16 v[98:99], v120 offset:6016
    ds_read_b64_tr_b16 v[100:101], v121 offset:5760
    v_mfma_f32_32x32x16_bf16 v[40:55], v[108:111], v[36:39], v[40:55]
    ds_read_b128 v[104:107], v122 offset:4864
    ds_read_b128 v[108:111], v123 offset:4864
    s_cmp_eq_u32 s10, 0
    s_cbranch_scc1 L_k2_nd2
    s_add_u32 m0, s27, 23552
    s_add_u32 s19, s26, 23552
    buffer_load_dwordx4 v7, s[20:23], s19 offen lds
    s_add_u32 m0, s27, 24576
    s_add_u32 s19, s26, 24576
    buffer_load_dwordx4 v7, s[20:23], s19 offen lds
    s_add_u32 m0, s27, 25600
    s_add_u32 s19, s26, 25600
    buffer_load_dwordx4 v7, s[20:23], s19 offen lds
L_k2_nd2:
    v_exp_f32 v72, v72
    v_exp_f32 v73, v73
    v_exp_f32 v74, v74
    s_waitcnt lgkmcnt(5)
    v_mfma_f32_32x32x16_bf16 v[56:71], v[88:91], v[8:11], v[16:31]
    v_exp_f32 v75, v75
    v_exp_f32 v76, v76
    v_exp_f32 v77, v77
    v_cvt_pk_bf16_f32 v32, v72, v73
    v_exp_f32 v78, v78
    v_exp_f32 v79, v79
    v_cvt_pk_bf16_f32 v33, v74, v75
    v_mfma_f32_32x32x16_bf16 v[56:71], v[92:95], v[12:15], v[56:71]
    v_exp_f32 v80, v80
    v_exp_f32 v81, v81
    v_cvt_pk_bf16_f32 v34, v76, v77
    v_exp_f32 v82, v82
    v_exp_f32 v83, v83
    v_cvt_pk_bf16_f32 v35, v78, v79
    v_exp_f32 v84, v84
    v_exp_f32 v85, v85
    v_mfma_f32_32x32x16_bf16 v[40:55], v[112:115], v[32:35], v[40:55]
    v_cvt_pk_bf16_f32 v36, v80, v81
    v_exp_f32 v86, v86
    v_exp_f32 v87, v87
    v_cvt_pk_bf16_f32 v37, v82, v83
    s_nop 0
    v_cvt_pk_bf16_f32 v38, v84, v85
    v_cvt_pk_bf16_f32 v39, v86, v87
    s_cmp_gt_u32 s29, 1
    s_cbranch_scc1 L_k2_nopoll
    s_cmp_eq_u32 s29, 0
    s_cbranch_scc0 L_k2_pollc
    s_lshl_b32 s37, s6, 2
    s_add_u32 s37, s37, 4
    v_mov_b32 v4, 160776
L_k2_pollB:
    ds_read_b32 v5, v4
    s_waitcnt lgkmcnt(0)
    v_readfirstlane_b32 s38, v5
    s_nop 3
    s_cmp_ge_u32 s38, s37
    s_cbranch_scc0 L_k2_pollB
    s_branch L_k2_nopoll
L_k2_pollc:
    s_lshl_b32 s37, s6, 2
    s_add_u32 s37, s37, 4
    v_mov_b32 v4, 160780
L_k2_pollC:
    ds_read_b32 v5, v4
    s_waitcnt lgkmcnt(0)
    v_readfirstlane_b32 s38, v5
    s_nop 3
    s_cmp_ge_u32 s38, s37
    s_cbranch_scc0 L_k2_pollC
    s_cmp_lt_u32 s3, 4
    s_cbranch_scc1 L_k2_prb
    s_setprio 1
    s_branch L_k2_pqb
L_k2_prb:
    s_setprio 2
L_k2_pqb:
L_k2_nopoll:
    ds_read_b64_tr_b16 v[88:89], v120 offset:6912
    ds_read_b64_tr_b16 v[90:91], v120 offset:7168
    ds_read_b64_tr_b16 v[92:93], v121 offset:6912
    v_mfma_f32_32x32x16_bf16 v[40:55], v[116:119], v[36:39], v[40:55]
    ds_read_b128 v[112:115], v122 offset:6080
    ds_read_b128 v[116:119], v123 offset:6080
    s_cmp_eq_u32 s10, 0
    s_cbranch_scc1 L_k2_nd3
    s_add_u32 m0, s27, 26624
    s_add_u32 s19, s26, 26624
    buffer_load_dwordx4 v7, s[20:23], s19 offen lds
    s_add_u32 m0, s27, 27648
    s_add_u32 s19, s26, 27648
    buffer_load_dwordx4 v7, s[20:23], s19 offen lds
    s_add_u32 m0, s27, 28672
    s_add_u32 s19, s26, 28672
    buffer_load_dwordx4 v7, s[20:23], s19 offen lds
L_k2_nd3:
    v_exp_f32 v56, v56
    v_exp_f32 v57, v57
    v_exp_f32 v58, v58
    s_waitcnt lgkmcnt(5)
    v_mfma_f32_32x32x16_bf16 v[72:87], v[96:99], v[8:11], v[16:31]
    v_exp_f32 v59, v59
    v_exp_f32 v60, v60
    v_exp_f32 v61, v61
    v_cvt_pk_bf16_f32 v32, v56, v57
    v_exp_f32 v62, v62
    v_exp_f32 v63, v63
    v_cvt_pk_bf16_f32 v33, v58, v59
    v_mfma_f32_32x32x16_bf16 v[72:87], v[100:103], v[12:15], v[72:87]
    v_exp_f32 v64, v64
    v_exp_f32 v65, v65
    v_cvt_pk_bf16_f32 v34, v60, v61
    v_exp_f32 v66, v66
    v_exp_f32 v67, v67
    v_cvt_pk_bf16_f32 v35, v62, v63
    v_exp_f32 v68, v68
    v_exp_f32 v69, v69
    v_mfma_f32_32x32x16_bf16 v[40:55], v[104:107], v[32:35], v[40:55]
    v_cvt_pk_bf16_f32 v36, v64, v65
    v_exp_f32 v70, v70
    v_exp_f32 v71, v71
    v_cvt_pk_bf16_f32 v37, v66, v67
    s_nop 0
    v_cvt_pk_bf16_f32 v38, v68, v69
    v_cvt_pk_bf16_f32 v39, v70, v71
    ds_read_b64_tr_b16 v[96:97], v120 offset:8064
    ds_read_b64_tr_b16 v[98:99], v120 offset:8320
    ds_read_b64_tr_b16 v[100:101], v121 offset:8064
    v_mfma_f32_32x32x16_bf16 v[40:55], v[108:111], v[36:39], v[40:55]
    ds_read_b128 v[104:107], v122 offset:7296
    ds_read_b128 v[108:111], v123 offset:7296
    s_cmp_eq_u32 s10, 0
    s_cbranch_scc1 L_k2_nd4
    s_add_u32 m0, s27, 29696
    s_add_u32 s19, s26, 29696
    buffer_load_dwordx4 v7, s[20:23], s19 offen lds
    s_add_u32 m0, s27, 30720
    s_add_u32 s19, s26, 30720
    buffer_load_dwordx4 v7, s[20:23], s19 offen lds
    s_add_u32 m0, s27, 31744
    s_add_u32 s19, s26, 31744
    buffer_load_dwordx4 v7, s[20:23], s19 offen lds
L_k2_nd4:
    v_exp_f32 v72, v72
    v_exp_f32 v73, v73
    v_exp_f32 v74, v74
    s_waitcnt lgkmcnt(5)
    v_mfma_f32_32x32x16_bf16 v[56:71], v[88:91], v[8:11], v[16:31]
    v_exp_f32 v75, v75
    v_exp_f32 v76, v76
    v_exp_f32 v77, v77
    v_cvt_pk_bf16_f32 v32, v72, v73
    v_exp_f32 v78, v78
    v_exp_f32 v79, v79
    v_cvt_pk_bf16_f32 v33, v74, v75
    v_mfma_f32_32x32x16_bf16 v[56:71], v[92:95], v[12:15], v[56:71]
    v_exp_f32 v80, v80
    v_exp_f32 v81, v81
    v_cvt_pk_bf16_f32 v34, v76, v77
    v_exp_f32 v82, v82
    v_exp_f32 v83, v83
    v_cvt_pk_bf16_f32 v35, v78, v79
    v_exp_f32 v84, v84
    v_exp_f32 v85, v85
    v_mfma_f32_32x32x16_bf16 v[40:55], v[112:115], v[32:35], v[40:55]
    v_cvt_pk_bf16_f32 v36, v80, v81
    v_exp_f32 v86, v86
    v_exp_f32 v87, v87
    v_cvt_pk_bf16_f32 v37, v82, v83
    s_nop 0
    v_cvt_pk_bf16_f32 v38, v84, v85
    v_cvt_pk_bf16_f32 v39, v86, v87
    ds_read_b64_tr_b16 v[88:89], v120 offset:9216
    ds_read_b64_tr_b16 v[90:91], v120 offset:9472
    ds_read_b64_tr_b16 v[92:93], v121 offset:9216
    v_mfma_f32_32x32x16_bf16 v[40:55], v[116:119], v[36:39], v[40:55]
    ds_read_b128 v[112:115], v122 offset:8512
    ds_read_b128 v[116:119], v123 offset:8512
    s_cmp_eq_u32 s10, 0
    s_cbranch_scc1 L_k2_nd5
    s_add_u32 m0, s27, 32768
    s_add_u32 s19, s26, 32768
    buffer_load_dwordx4 v7, s[20:23], s19 offen lds
    s_add_u32 m0, s27, 33792
    s_add_u32 s19, s26, 33792
    buffer_load_dwordx4 v7, s[20:23], s19 offen lds
    s_add_u32 m0, s27, 34816
    s_add_u32 s19, s26, 34816
    buffer_load_dwordx4 v7, s[20:23], s19 offen lds
L_k2_nd5:
    v_exp_f32 v56, v56
    v_exp_f32 v57, v57
    v_exp_f32 v58, v58
    s_waitcnt lgkmcnt(5)
    v_mfma_f32_32x32x16_bf16 v[72:87], v[96:99], v[8:11], v[16:31]
    v_exp_f32 v59, v59
    v_exp_f32 v60, v60
    v_exp_f32 v61, v61
    v_cvt_pk_bf16_f32 v32, v56, v57
    v_exp_f32 v62, v62
    v_exp_f32 v63, v63
    v_cvt_pk_bf16_f32 v33, v58, v59
    v_mfma_f32_32x32x16_bf16 v[72:87], v[100:103], v[12:15], v[72:87]
    v_exp_f32 v64, v64
    v_exp_f32 v65, v65
    v_cvt_pk_bf16_f32 v34, v60, v61
    v_exp_f32 v66, v66
    v_exp_f32 v67, v67
    v_cvt_pk_bf16_f32 v35, v62, v63
    v_exp_f32 v68, v68
    v_exp_f32 v69, v69
    v_mfma_f32_32x32x16_bf16 v[40:55], v[104:107], v[32:35], v[40:55]
    v_cvt_pk_bf16_f32 v36, v64, v65
    v_exp_f32 v70, v70
    v_exp_f32 v71, v71
    v_cvt_pk_bf16_f32 v37, v66, v67
    s_nop 0
    v_cvt_pk_bf16_f32 v38, v68, v69
    v_cvt_pk_bf16_f32 v39, v70, v71
    ds_read_b64_tr_b16 v[96:97], v120 offset:10368
    ds_read_b64_tr_b16 v[98:99], v120 offset:10624
    ds_read_b64_tr_b16 v[100:101], v121 offset:10368
    v_mfma_f32_32x32x16_bf16 v[40:55], v[108:111], v[36:39], v[40:55]
    ds_read_b128 v[104:107], v122 offset:9728
    ds_read_b128 v[108:111], v123 offset:9728
    s_cmp_eq_u32 s10, 0
    s_cbranch_scc1 L_k2_nd6
    s_add_u32 m0, s27, 35840
    s_add_u32 s19, s26, 35840
    buffer_load_dwordx4 v7, s[20:23], s19 offen lds
    s_min_u32 s18, s36, 36
    s_lshl_b32 s18, s18, 10
    s_add_u32 m0, s27, s18
    s_add_u32 s19, s26, s18
    buffer_load_dwordx4 v7, s[20:23], s19 offen lds
    s_min_u32 s18, s36, 37
    s_lshl_b32 s18, s18, 10
    s_add_u32 m0, s27, s18
    s_add_u32 s19, s26, s18
    buffer_load_dwordx4 v7, s[20:23], s19 offen lds
L_k2_nd6:
    v_exp_f32 v72, v72
    v_exp_f32 v73, v73
    v_exp_f32 v74, v74
    s_waitcnt lgkmcnt(5)
    v_mfma_f32_32x32x16_bf16 v[56:71], v[88:91], v[8:11], v[16:31]
    v_exp_f32 v75, v75
    v_exp_f32 v76, v76
    v_exp_f32 v77, v77
    v_cvt_pk_bf16_f32 v32, v72, v73
    v_exp_f32 v78, v78
    v_exp_f32 v79, v79
    v_cvt_pk_bf16_f32 v33, v74, v75
    v_mfma_f32_32x32x16_bf16 v[56:71], v[92:95], v[12:15], v[56:71]
    v_exp_f32 v80, v80
    v_exp_f32 v81, v81
    v_cvt_pk_bf16_f32 v34, v76, v77
    v_exp_f32 v82, v82
    v_exp_f32 v83, v83
    v_cvt_pk_bf16_f32 v35, v78, v79
    v_exp_f32 v84, v84
    v_exp_f32 v85, v85
    v_mfma_f32_32x32x16_bf16 v[40:55], v[112:115], v[32:35], v[40:55]
    v_cvt_pk_bf16_f32 v36, v80, v81
    v_exp_f32 v86, v86
    v_exp_f32 v87, v87
    v_cvt_pk_bf16_f32 v37, v82, v83
    s_nop 0
    v_cvt_pk_bf16_f32 v38, v84, v85
    v_cvt_pk_bf16_f32 v39, v86, v87
    v_add_u32 v120, 9216, v120
    v_add_u32 v121, 9216, v121
    v_add_u32 v122, 9728, v122
    v_add_u32 v123, 9728, v123
    s_add_u32 s29, s29, 1
    s_cmp_lt_u32 s29, 4
    s_cbranch_scc1 L_k2_loop
    v_mfma_f32_32x32x16_bf16 v[40:55], v[116:119], v[36:39], v[40:55]
    s_waitcnt lgkmcnt(0)
    s_cmp_eq_u32 s8, 0
    s_cbranch_scc1 L_k2_noscan
    s_nop 7
    s_lshl_b32 s44, s2, 2
    s_add_u32 s44, s44, s3
    s_mul_i32 s46, s44, 683
    s_lshr_b32 s46, s46, 16
    s_mul_i32 s47, s46, 96
    s_add_u32 s47, s47, s44
    s_lshl_b32 s47, s47, 6
    s_add_u32 s47, s47, 7208960
    s_add_u32 s48, s47, 6144
    s_mov_b32 s49, 73728
    v_mul_lo_u32 v3, v2, s49
    buffer_load_dwordx4 v[8:11], v3, s[20:23], s47 offen offset:0
    buffer_load_dwordx4 v[12:15], v3, s[20:23], s47 offen offset:16
    buffer_load_dwordx4 v[16:19], v3, s[20:23], s47 offen offset:32
    buffer_load_dwordx4 v[20:23], v3, s[20:23], s47 offen offset:48
    buffer_load_dwordx4 v[24:27], v3, s[20:23], s48 offen offset:0
    buffer_load_dwordx4 v[28:31], v3, s[20:23], s48 offen offset:16
    buffer_load_dwordx4 v[32:35], v3, s[20:23], s48 offen offset:32
    buffer_load_dwordx4 v[36:39], v3, s[20:23], s48 offen offset:48
    s_mul_i32 s50, s44, 528
    s_add_u32 s50, s50, 16277504
    v_and_b32 v126, 15, v2
    v_lshlrev_b32 v126, 3, v126
    v_and_b32 v127, 31, v2
    v_lshlrev_b32 v127, 3, v127
    buffer_load_dwordx2 v[4:5], v126, s[20:23], s50 offen offset:8
    buffer_load_dwordx2 v[124:125], v127, s[20:23], s50 offen offset:8
    s_add_u32 s52, s40, s50
    s_addc_u32 s53, s41, 0
    s_load_dwordx4 s[56:59], s[52:53], 8
    s_load_dwordx2 s[60:61], s[52:53], 32
    s_load_dwordx2 s[62:63], s[52:53], 64
    s_load_dwordx2 s[64:65], s[52:53], 520
    s_waitcnt vmcnt(0)
    s_waitcnt lgkmcnt(0)
    v_lshlrev_b32 v56, 16, v8
    v_lshlrev_b32 v57, 16, v24
    v_and_b32 v58, 0xffff0000, v8
    v_and_b32 v59, 0xffff0000, v24
    v_lshlrev_b32 v60, 16, v9
    v_lshlrev_b32 v61, 16, v25
    v_and_b32 v62, 0xffff0000, v9
    v_and_b32 v63, 0xffff0000, v25
    v_lshlrev_b32 v64, 16, v10
    v_lshlrev_b32 v65, 16, v26
    v_and_b32 v66, 0xffff0000, v10
    v_and_b32 v67, 0xffff0000, v26
    v_lshlrev_b32 v68, 16, v11
    v_lshlrev_b32 v69, 16, v27
    v_and_b32 v70, 0xffff0000, v11
    v_and_b32 v71, 0xffff0000, v27
    v_lshlrev_b32 v72, 16, v12
    v_lshlrev_b32 v73, 16, v28
    v_and_b32 v74, 0xffff0000, v12
    v_and_b32 v75, 0xffff0000, v28
    v_lshlrev_b32 v76, 16, v13
    v_lshlrev_b32 v77, 16, v29
    v_and_b32 v78, 0xffff0000, v13
    v_and_b32 v79, 0xffff0000, v29
    v_lshlrev_b32 v80, 16, v14
    v_lshlrev_b32 v81, 16, v30
    v_and_b32 v82, 0xffff0000, v14
    v_and_b32 v83, 0xffff0000, v30
    v_lshlrev_b32 v84, 16, v15
    v_lshlrev_b32 v85, 16, v31
    v_and_b32 v86, 0xffff0000, v15
    v_and_b32 v87, 0xffff0000, v31
    v_lshlrev_b32 v88, 16, v16
    v_lshlrev_b32 v89, 16, v32
    v_and_b32 v90, 0xffff0000, v16
    v_and_b32 v91, 0xffff0000, v32
    v_lshlrev_b32 v92, 16, v17
    v_lshlrev_b32 v93, 16, v33
    v_and_b32 v94, 0xffff0000, v17
    v_and_b32 v95, 0xffff0000, v33
    v_lshlrev_b32 v96, 16, v18
    v_lshlrev_b32 v97, 16, v34
    v_and_b32 v98, 0xffff0000, v18
    v_and_b32 v99, 0xffff0000, v34
    v_lshlrev_b32 v100, 16, v19
    v_lshlrev_b32 v101, 16, v35
    v_and_b32 v102, 0xffff0000, v19
    v_and_b32 v103, 0xffff0000, v35
    v_lshlrev_b32 v104, 16, v20
    v_lshlrev_b32 v105, 16, v36
    v_and_b32 v106, 0xffff0000, v20
    v_and_b32 v107, 0xffff0000, v36
    v_lshlrev_b32 v108, 16, v21
    v_lshlrev_b32 v109, 16, v37
    v_and_b32 v110, 0xffff0000, v21
    v_and_b32 v111, 0xffff0000, v37
    v_lshlrev_b32 v112, 16, v22
    v_lshlrev_b32 v113, 16, v38
    v_and_b32 v114, 0xffff0000, v22
    v_and_b32 v115, 0xffff0000, v38
    v_lshlrev_b32 v116, 16, v23
    v_lshlrev_b32 v117, 16, v39
    v_and_b32 v118, 0xffff0000, v23
    v_and_b32 v119, 0xffff0000, v39
    v_mov_b32 v120, v56
    v_mov_b32 v121, v57
    v_pk_fma_f32 v[126:127], s[64:65], v[120:121], v[58:59] op_sel:[0,0,0] op_sel_hi:[0,1,1]
    v_pk_fma_f32 v[126:127], s[64:65], v[120:121], v[126:127] op_sel:[1,1,0] op_sel_hi:[1,0,1] neg_lo:[1,0,0]
    v_pk_fma_f32 v[120:121], s[64:65], v[126:127], v[60:61] op_sel:[0,0,0] op_sel_hi:[0,1,1]
    v_pk_fma_f32 v[120:121], s[64:65], v[126:127], v[120:121] op_sel:[1,1,0] op_sel_hi:[1,0,1] neg_lo:[1,0,0]
    v_pk_fma_f32 v[126:127], s[64:65], v[120:121], v[62:63] op_sel:[0,0,0] op_sel_hi:[0,1,1]
    v_pk_fma_f32 v[126:127], s[64:65], v[120:121], v[126:127] op_sel:[1,1,0] op_sel_hi:[1,0,1] neg_lo:[1,0,0]
    v_pk_fma_f32 v[120:121], s[64:65], v[126:127], v[64:65] op_sel:[0,0,0] op_sel_hi:[0,1,1]
    v_pk_fma_f32 v[120:121], s[64:65], v[126:127], v[120:121] op_sel:[1,1,0] op_sel_hi:[1,0,1] neg_lo:[1,0,0]
    v_pk_fma_f32 v[126:127], s[64:65], v[120:121], v[66:67] op_sel:[0,0,0] op_sel_hi:[0,1,1]
    v_pk_fma_f32 v[126:127], s[64:65], v[120:121], v[126:127] op_sel:[1,1,0] op_sel_hi:[1,0,1] neg_lo:[1,0,0]
    v_pk_fma_f32 v[120:121], s[64:65], v[126:127], v[68:69] op_sel:[0,0,0] op_sel_hi:[0,1,1]
    v_pk_fma_f32 v[120:121], s[64:65], v[126:127], v[120:121] op_sel:[1,1,0] op_sel_hi:[1,0,1] neg_lo:[1,0,0]
    v_pk_fma_f32 v[126:127], s[64:65], v[120:121], v[70:71] op_sel:[0,0,0] op_sel_hi:[0,1,1]
    v_pk_fma_f32 v[126:127], s[64:65], v[120:121], v[126:127] op_sel:[1,1,0] op_sel_hi:[1,0,1] neg_lo:[1,0,0]
    v_pk_fma_f32 v[120:121], s[64:65], v[126:127], v[72:73] op_sel:[0,0,0] op_sel_hi:[0,1,1]
    v_pk_fma_f32 v[120:121], s[64:65], v[126:127], v[120:121] op_sel:[1,1,0] op_sel_hi:[1,0,1] neg_lo:[1,0,0]
    v_pk_fma_f32 v[126:127], s[64:65], v[120:121], v[74:75] op_sel:[0,0,0] op_sel_hi:[0,1,1]
    v_pk_fma_f32 v[126:127], s[64:65], v[120:121], v[126:127] op_sel:[1,1,0] op_sel_hi:[1,0,1] neg_lo:[1,0,0]
    v_pk_fma_f32 v[120:121], s[64:65], v[126:127], v[76:77] op_sel:[0,0,0] op_sel_hi:[0,1,1]
    v_pk_fma_f32 v[120:121], s[64:65], v[126:127], v[120:121] op_sel:[1,1,0] op_sel_hi:[1,0,1] neg_lo:[1,0,0]
    v_pk_fma_f32 v[126:127], s[64:65], v[120:121], v[78:79] op_sel:[0,0,0] op_sel_hi:[0,1,1]
    v_pk_fma_f32 v[126:127], s[64:65], v[120:121], v[126:127] op_sel:[1,1,0] op_sel_hi:[1,0,1] neg_lo:[1,0,0]
    v_pk_fma_f32 v[120:121], s[64:65], v[126:127], v[80:81] op_sel:[0,0,0] op_sel_hi:[0,1,1]
    v_pk_fma_f32 v[120:121], s[64:65], v[126:127], v[120:121] op_sel:[1,1,0] op_sel_hi:[1,0,1] neg_lo:[1,0,0]
    v_pk_fma_f32 v[126:127], s[64:65], v[120:121], v[82:83] op_sel:[0,0,0] op_sel_hi:[0,1,1]
    v_pk_fma_f32 v[126:127], s[64:65], v[120:121], v[126:127] op_sel:[1,1,0] op_sel_hi:[1,0,1] neg_lo:[1,0,0]
    v_pk_fma_f32 v[120:121], s[64:65], v[126:127], v[84:85] op_sel:[0,0,0] op_sel_hi:[0,1,1]
    v_pk_fma_f32 v[120:121], s[64:65], v[126:127], v[120:121] op_sel:[1,1,0] op_sel_hi:[1,0,1] neg_lo:[1,0,0]
    v_pk_fma_f32 v[126:127], s[64:65], v[120:121], v[86:87] op_sel:[0,0,0] op_sel_hi:[0,1,1]
    v_pk_fma_f32 v[126:127], s[64:65], v[120:121], v[126:127] op_sel:[1,1,0] op_sel_hi:[1,0,1] neg_lo:[1,0,0]
    v_pk_fma_f32 v[120:121], s[64:65], v[126:127], v[88:89] op_sel:[0,0,0] op_sel_hi:[0,1,1]
    v_pk_fma_f32 v[120:121], s[64:65], v[126:127], v[120:121] op_sel:[1,1,0] op_sel_hi:[1,0,1] neg_lo:[1,0,0]
    v_pk_fma_f32 v[126:127], s[64:65], v[120:121], v[90:91] op_sel:[0,0,0] op_sel_hi:[0,1,1]
    v_pk_fma_f32 v[126:127], s[64:65], v[120:121], v[126:127] op_sel:[1,1,0] op_sel_hi:[1,0,1] neg_lo:[1,0,0]
    v_pk_fma_f32 v[120:121], s[64:65], v[126:127], v[92:93] op_sel:[0,0,0] op_sel_hi:[0,1,1]
    v_pk_fma_f32 v[120:121], s[64:65], v[126:127], v[120:121] op_sel:[1,1,0] op_sel_hi:[1,0,1] neg_lo:[1,0,0]
    v_pk_fma_f32 v[126:127], s[64:65], v[120:121], v[94:95] op_sel:[0,0,0] op_sel_hi:[0,1,1]
    v_pk_fma_f32 v[126:127], s[64:65], v[120:121], v[126:127] op_sel:[1,1,0] op_sel_hi:[1,0,1] neg_lo:[1,0,0]
    v_pk_fma_f32 v[120:121], s[64:65], v[126:127], v[96:97] op_sel:[0,0,0] op_sel_hi:[0,1,1]
    v_pk_fma_f32 v[120:121], s[64:65], v[126:127], v[120:121] op_sel:[1,1,0] op_sel_hi:[1,0,1] neg_lo:[1,0,0]
    v_pk_fma_f32 v[126:127], s[64:65], v[120:121], v[98:99] op_sel:[0,0,0] op_sel_hi:[0,1,1]
    v_pk_fma_f32 v[126:127], s[64:65], v[120:121], v[126:127] op_sel:[1,1,0] op_sel_hi:[1,0,1] neg_lo:[1,0,0]
    v_pk_fma_f32 v[120:121], s[64:65], v[126:127], v[100:101] op_sel:[0,0,0] op_sel_hi:[0,1,1]
    v_pk_fma_f32 v[120:121], s[64:65], v[126:127], v[120:121] op_sel:[1,1,0] op_sel_hi:[1,0,1] neg_lo:[1,0,0]
    v_pk_fma_f32 v[126:127], s[64:65], v[120:121], v[102:103] op_sel:[0,0,0] op_sel_hi:[0,1,1]
    v_pk_fma_f32 v[126:127], s[64:65], v[120:121], v[126:127] op_sel:[1,1,0] op_sel_hi:[1,0,1] neg_lo:[1,0,0]
    v_pk_fma_f32 v[120:121], s[64:65], v[126:127], v[104:105] op_sel:[0,0,0] op_sel_hi:[0,1,1]
    v_pk_fma_f32 v[120:121], s[64:65], v[126:127], v[120:121] op_sel:[1,1,0] op_sel_hi:[1,0,1] neg_lo:[1,0,0]
    v_pk_fma_f32 v[126:127], s[64:65], v[120:121], v[106:107] op_sel:[0,0,0] op_sel_hi:[0,1,1]
    v_pk_fma_f32 v[126:127], s[64:65], v[120:121], v[126:127] op_sel:[1,1,0] op_sel_hi:[1,0,1] neg_lo:[1,0,0]
    v_pk_fma_f32 v[120:121], s[64:65], v[126:127], v[108:109] op_sel:[0,0,0] op_sel_hi:[0,1,1]
    v_pk_fma_f32 v[120:121], s[64:65], v[126:127], v[120:121] op_sel:[1,1,0] op_sel_hi:[1,0,1] neg_lo:[1,0,0]
    v_pk_fma_f32 v[126:127], s[64:65], v[120:121], v[110:111] op_sel:[0,0,0] op_sel_hi:[0,1,1]
    v_pk_fma_f32 v[126:127], s[64:65], v[120:121], v[126:127] op_sel:[1,1,0] op_sel_hi:[1,0,1] neg_lo:[1,0,0]
    v_pk_fma_f32 v[120:121], s[64:65], v[126:127], v[112:113] op_sel:[0,0,0] op_sel_hi:[0,1,1]
    v_pk_fma_f32 v[120:121], s[64:65], v[126:127], v[120:121] op_sel:[1,1,0] op_sel_hi:[1,0,1] neg_lo:[1,0,0]
    v_pk_fma_f32 v[126:127], s[64:65], v[120:121], v[114:115] op_sel:[0,0,0] op_sel_hi:[0,1,1]
    v_pk_fma_f32 v[126:127], s[64:65], v[120:121], v[126:127] op_sel:[1,1,0] op_sel_hi:[1,0,1] neg_lo:[1,0,0]
    v_pk_fma_f32 v[120:121], s[64:65], v[126:127], v[116:117] op_sel:[0,0,0] op_sel_hi:[0,1,1]
    v_pk_fma_f32 v[120:121], s[64:65], v[126:127], v[120:121] op_sel:[1,1,0] op_sel_hi:[1,0,1] neg_lo:[1,0,0]
    v_pk_fma_f32 v[126:127], s[64:65], v[120:121], v[118:119] op_sel:[0,0,0] op_sel_hi:[0,1,1]
    v_pk_fma_f32 v[126:127], s[64:65], v[120:121], v[126:127] op_sel:[1,1,0] op_sel_hi:[1,0,1] neg_lo:[1,0,0]
    s_nop 1
    v_mov_b32_dpp v122, v126 row_shr:1 row_mask:0xf bank_mask:0xf bound_ctrl:0
    v_mov_b32_dpp v123, v127 row_shr:1 row_mask:0xf bank_mask:0xf bound_ctrl:0
    v_pk_fma_f32 v[126:127], s[56:57], v[122:123], v[126:127] op_sel:[0,0,0] op_sel_hi:[0,1,1]
    v_pk_fma_f32 v[126:127], s[56:57], v[122:123], v[126:127] op_sel:[1,1,0] op_sel_hi:[1,0,1] neg_lo:[1,0,0]
    s_nop 1
    v_mov_b32_dpp v122, v126 row_shr:2 row_mask:0xf bank_mask:0xf bound_ctrl:0
    v_mov_b32_dpp v123, v127 row_shr:2 row_mask:0xf bank_mask:0xf bound_ctrl:0
    v_pk_fma_f32 v[126:127], s[58:59], v[122:123], v[126:127] op_sel:[0,0,0] op_sel_hi:[0,1,1]
    v_pk_fma_f32 v[126:127], s[58:59], v[122:123], v[126:127] op_sel:[1,1,0] op_sel_hi:[1,0,1] neg_lo:[1,0,0]
    s_nop 1
    v_mov_b32_dpp v122, v126 row_shr:4 row_mask:0xf bank_mask:0xf bound_ctrl:0
    v_mov_b32_dpp v123, v127 row_shr:4 row_mask:0xf bank_mask:0xf bound_ctrl:0
    v_pk_fma_f32 v[126:127], s[60:61], v[122:123], v[126:127] op_sel:[0,0,0] op_sel_hi:[0,1,1]
    v_pk_fma_f32 v[126:127], s[60:61], v[122:123], v[126:127] op_sel:[1,1,0] op_sel_hi:[1,0,1] neg_lo:[1,0,0]
    s_nop 1
    v_mov_b32_dpp v122, v126 row_shr:8 row_mask:0xf bank_mask:0xf bound_ctrl:0
    v_mov_b32_dpp v123, v127 row_shr:8 row_mask:0xf bank_mask:0xf bound_ctrl:0
    v_pk_fma_f32 v[126:127], s[62:63], v[122:123], v[126:127] op_sel:[0,0,0] op_sel_hi:[0,1,1]
    v_pk_fma_f32 v[126:127], s[62:63], v[122:123], v[126:127] op_sel:[1,1,0] op_sel_hi:[1,0,1] neg_lo:[1,0,0]
    v_mov_b32 v122, 0
    v_mov_b32 v123, 0
    s_nop 1
    v_mov_b32_dpp v122, v126 row_bcast:15 row_mask:0xa bank_mask:0xf
    v_mov_b32_dpp v123, v127 row_bcast:15 row_mask:0xa bank_mask:0xf
    v_pk_fma_f32 v[126:127], v[4:5], v[122:123], v[126:127] op_sel:[0,0,0] op_sel_hi:[0,1,1]
    v_pk_fma_f32 v[126:127], v[4:5], v[122:123], v[126:127] op_sel:[1,1,0] op_sel_hi:[1,0,1] neg_lo:[1,0,0]
    v_mov_b32 v122, 0
    v_mov_b32 v123, 0
    s_nop 1
    v_mov_b32_dpp v122, v126 row_bcast:31 row_mask:0xc bank_mask:0xf
    v_mov_b32_dpp v123, v127 row_bcast:31 row_mask:0xc bank_mask:0xf
    v_pk_fma_f32 v[126:127], v[124:125], v[122:123], v[126:127] op_sel:[0,0,0] op_sel_hi:[0,1,1]
    v_pk_fma_f32 v[126:127], v[124:125], v[122:123], v[126:127] op_sel:[1,1,0] op_sel_hi:[1,0,1] neg_lo:[1,0,0]
    v_mov_b32 v122, 0
    v_mov_b32 v123, 0
    s_nop 1
    v_mov_b32_dpp v122, v126 wave_shr:1 row_mask:0xf bank_mask:0xf
    v_mov_b32_dpp v123, v127 wave_shr:1 row_mask:0xf bank_mask:0xf
    v_pk_fma_f32 v[56:57], s[64:65], v[122:123], v[56:57] op_sel:[0,0,0] op_sel_hi:[0,1,1]
    v_pk_fma_f32 v[56:57], s[64:65], v[122:123], v[56:57] op_sel:[1,1,0] op_sel_hi:[1,0,1] neg_lo:[1,0,0]
    v_pk_fma_f32 v[58:59], s[64:65], v[56:57], v[58:59] op_sel:[0,0,0] op_sel_hi:[0,1,1]
    v_pk_fma_f32 v[58:59], s[64:65], v[56:57], v[58:59] op_sel:[1,1,0] op_sel_hi:[1,0,1] neg_lo:[1,0,0]
    v_cvt_pk_bf16_f32 v8, v56, v58
    v_cvt_pk_bf16_f32 v24, v57, v59
    v_pk_fma_f32 v[60:61], s[64:65], v[58:59], v[60:61] op_sel:[0,0,0] op_sel_hi:[0,1,1]
    v_pk_fma_f32 v[60:61], s[64:65], v[58:59], v[60:61] op_sel:[1,1,0] op_sel_hi:[1,0,1] neg_lo:[1,0,0]
    v_pk_fma_f32 v[62:63], s[64:65], v[60:61], v[62:63] op_sel:[0,0,0] op_sel_hi:[0,1,1]
    v_pk_fma_f32 v[62:63], s[64:65], v[60:61], v[62:63] op_sel:[1,1,0] op_sel_hi:[1,0,1] neg_lo:[1,0,0]
    v_cvt_pk_bf16_f32 v9, v60, v62
    v_cvt_pk_bf16_f32 v25, v61, v63
    v_pk_fma_f32 v[64:65], s[64:65], v[62:63], v[64:65] op_sel:[0,0,0] op_sel_hi:[0,1,1]
    v_pk_fma_f32 v[64:65], s[64:65], v[62:63], v[64:65] op_sel:[1,1,0] op_sel_hi:[1,0,1] neg_lo:[1,0,0]
    v_pk_fma_f32 v[66:67], s[64:65], v[64:65], v[66:67] op_sel:[0,0,0] op_sel_hi:[0,1,1]
    v_pk_fma_f32 v[66:67], s[64:65], v[64:65], v[66:67] op_sel:[1,1,0] op_sel_hi:[1,0,1] neg_lo:[1,0,0]
    v_cvt_pk_bf16_f32 v10, v64, v66
    v_cvt_pk_bf16_f32 v26, v65, v67
    v_pk_fma_f32 v[68:69], s[64:65], v[66:67], v[68:69] op_sel:[0,0,0] op_sel_hi:[0,1,1]
    v_pk_fma_f32 v[68:69], s[64:65], v[66:67], v[68:69] op_sel:[1,1,0] op_sel_hi:[1,0,1] neg_lo:[1,0,0]
    v_pk_fma_f32 v[70:71], s[64:65], v[68:69], v[70:71] op_sel:[0,0,0] op_sel_hi:[0,1,1]
    v_pk_fma_f32 v[70:71], s[64:65], v[68:69], v[70:71] op_sel:[1,1,0] op_sel_hi:[1,0,1] neg_lo:[1,0,0]
    v_cvt_pk_bf16_f32 v11, v68, v70
    v_cvt_pk_bf16_f32 v27, v69, v71
    v_pk_fma_f32 v[72:73], s[64:65], v[70:71], v[72:73] op_sel:[0,0,0] op_sel_hi:[0,1,1]
    v_pk_fma_f32 v[72:73], s[64:65], v[70:71], v[72:73] op_sel:[1,1,0] op_sel_hi:[1,0,1] neg_lo:[1,0,0]
    v_pk_fma_f32 v[74:75], s[64:65], v[72:73], v[74:75] op_sel:[0,0,0] op_sel_hi:[0,1,1]
    v_pk_fma_f32 v[74:75], s[64:65], v[72:73], v[74:75] op_sel:[1,1,0] op_sel_hi:[1,0,1] neg_lo:[1,0,0]
    v_cvt_pk_bf16_f32 v12, v72, v74
    v_cvt_pk_bf16_f32 v28, v73, v75
    v_pk_fma_f32 v[76:77], s[64:65], v[74:75], v[76:77] op_sel:[0,0,0] op_sel_hi:[0,1,1]
    v_pk_fma_f32 v[76:77], s[64:65], v[74:75], v[76:77] op_sel:[1,1,0] op_sel_hi:[1,0,1] neg_lo:[1,0,0]
    v_pk_fma_f32 v[78:79], s[64:65], v[76:77], v[78:79] op_sel:[0,0,0] op_sel_hi:[0,1,1]
    v_pk_fma_f32 v[78:79], s[64:65], v[76:77], v[78:79] op_sel:[1,1,0] op_sel_hi:[1,0,1] neg_lo:[1,0,0]
    v_cvt_pk_bf16_f32 v13, v76, v78
    v_cvt_pk_bf16_f32 v29, v77, v79
    v_pk_fma_f32 v[80:81], s[64:65], v[78:79], v[80:81] op_sel:[0,0,0] op_sel_hi:[0,1,1]
    v_pk_fma_f32 v[80:81], s[64:65], v[78:79], v[80:81] op_sel:[1,1,0] op_sel_hi:[1,0,1] neg_lo:[1,0,0]
    v_pk_fma_f32 v[82:83], s[64:65], v[80:81], v[82:83] op_sel:[0,0,0] op_sel_hi:[0,1,1]
    v_pk_fma_f32 v[82:83], s[64:65], v[80:81], v[82:83] op_sel:[1,1,0] op_sel_hi:[1,0,1] neg_lo:[1,0,0]
    v_cvt_pk_bf16_f32 v14, v80, v82
    v_cvt_pk_bf16_f32 v30, v81, v83
    v_pk_fma_f32 v[84:85], s[64:65], v[82:83], v[84:85] op_sel:[0,0,0] op_sel_hi:[0,1,1]
    v_pk_fma_f32 v[84:85], s[64:65], v[82:83], v[84:85] op_sel:[1,1,0] op_sel_hi:[1,0,1] neg_lo:[1,0,0]
    v_pk_fma_f32 v[86:87], s[64:65], v[84:85], v[86:87] op_sel:[0,0,0] op_sel_hi:[0,1,1]
    v_pk_fma_f32 v[86:87], s[64:65], v[84:85], v[86:87] op_sel:[1,1,0] op_sel_hi:[1,0,1] neg_lo:[1,0,0]
    v_cvt_pk_bf16_f32 v15, v84, v86
    v_cvt_pk_bf16_f32 v31, v85, v87
    v_pk_fma_f32 v[88:89], s[64:65], v[86:87], v[88:89] op_sel:[0,0,0] op_sel_hi:[0,1,1]
    v_pk_fma_f32 v[88:89], s[64:65], v[86:87], v[88:89] op_sel:[1,1,0] op_sel_hi:[1,0,1] neg_lo:[1,0,0]
    v_pk_fma_f32 v[90:91], s[64:65], v[88:89], v[90:91] op_sel:[0,0,0] op_sel_hi:[0,1,1]
    v_pk_fma_f32 v[90:91], s[64:65], v[88:89], v[90:91] op_sel:[1,1,0] op_sel_hi:[1,0,1] neg_lo:[1,0,0]
    v_cvt_pk_bf16_f32 v16, v88, v90
    v_cvt_pk_bf16_f32 v32, v89, v91
    v_pk_fma_f32 v[92:93], s[64:65], v[90:91], v[92:93] op_sel:[0,0,0] op_sel_hi:[0,1,1]
    v_pk_fma_f32 v[92:93], s[64:65], v[90:91], v[92:93] op_sel:[1,1,0] op_sel_hi:[1,0,1] neg_lo:[1,0,0]
    v_pk_fma_f32 v[94:95], s[64:65], v[92:93], v[94:95] op_sel:[0,0,0] op_sel_hi:[0,1,1]
    v_pk_fma_f32 v[94:95], s[64:65], v[92:93], v[94:95] op_sel:[1,1,0] op_sel_hi:[1,0,1] neg_lo:[1,0,0]
    v_cvt_pk_bf16_f32 v17, v92, v94
    v_cvt_pk_bf16_f32 v33, v93, v95
    v_pk_fma_f32 v[96:97], s[64:65], v[94:95], v[96:97] op_sel:[0,0,0] op_sel_hi:[0,1,1]
    v_pk_fma_f32 v[96:97], s[64:65], v[94:95], v[96:97] op_sel:[1,1,0] op_sel_hi:[1,0,1] neg_lo:[1,0,0]
    v_pk_fma_f32 v[98:99], s[64:65], v[96:97], v[98:99] op_sel:[0,0,0] op_sel_hi:[0,1,1]
    v_pk_fma_f32 v[98:99], s[64:65], v[96:97], v[98:99] op_sel:[1,1,0] op_sel_hi:[1,0,1] neg_lo:[1,0,0]
    v_cvt_pk_bf16_f32 v18, v96, v98
    v_cvt_pk_bf16_f32 v34, v97, v99
    v_pk_fma_f32 v[100:101], s[64:65], v[98:99], v[100:101] op_sel:[0,0,0] op_sel_hi:[0,1,1]
    v_pk_fma_f32 v[100:101], s[64:65], v[98:99], v[100:101] op_sel:[1,1,0] op_sel_hi:[1,0,1] neg_lo:[1,0,0]
    v_pk_fma_f32 v[102:103], s[64:65], v[100:101], v[102:103] op_sel:[0,0,0] op_sel_hi:[0,1,1]
    v_pk_fma_f32 v[102:103], s[64:65], v[100:101], v[102:103] op_sel:[1,1,0] op_sel_hi:[1,0,1] neg_lo:[1,0,0]
    v_cvt_pk_bf16_f32 v19, v100, v102
    v_cvt_pk_bf16_f32 v35, v101, v103
    v_pk_fma_f32 v[104:105], s[64:65], v[102:103], v[104:105] op_sel:[0,0,0] op_sel_hi:[0,1,1]
    v_pk_fma_f32 v[104:105], s[64:65], v[102:103], v[104:105] op_sel:[1,1,0] op_sel_hi:[1,0,1] neg_lo:[1,0,0]
    v_pk_fma_f32 v[106:107], s[64:65], v[104:105], v[106:107] op_sel:[0,0,0] op_sel_hi:[0,1,1]
    v_pk_fma_f32 v[106:107], s[64:65], v[104:105], v[106:107] op_sel:[1,1,0] op_sel_hi:[1,0,1] neg_lo:[1,0,0]
    v_cvt_pk_bf16_f32 v20, v104, v106
    v_cvt_pk_bf16_f32 v36, v105, v107
    v_pk_fma_f32 v[108:109], s[64:65], v[106:107], v[108:109] op_sel:[0,0,0] op_sel_hi:[0,1,1]
    v_pk_fma_f32 v[108:109], s[64:65], v[106:107], v[108:109] op_sel:[1,1,0] op_sel_hi:[1,0,1] neg_lo:[1,0,0]
    v_pk_fma_f32 v[110:111], s[64:65], v[108:109], v[110:111] op_sel:[0,0,0] op_sel_hi:[0,1,1]
    v_pk_fma_f32 v[110:111], s[64:65], v[108:109], v[110:111] op_sel:[1,1,0] op_sel_hi:[1,0,1] neg_lo:[1,0,0]
    v_cvt_pk_bf16_f32 v21, v108, v110
    v_cvt_pk_bf16_f32 v37, v109, v111
    v_pk_fma_f32 v[112:113], s[64:65], v[110:111], v[112:113] op_sel:[0,0,0] op_sel_hi:[0,1,1]
    v_pk_fma_f32 v[112:113], s[64:65], v[110:111], v[112:113] op_sel:[1,1,0] op_sel_hi:[1,0,1] neg_lo:[1,0,0]
    v_pk_fma_f32 v[114:115], s[64:65], v[112:113], v[114:115] op_sel:[0,0,0] op_sel_hi:[0,1,1]
    v_pk_fma_f32 v[114:115], s[64:65], v[112:113], v[114:115] op_sel:[1,1,0] op_sel_hi:[1,0,1] neg_lo:[1,0,0]
    v_cvt_pk_bf16_f32 v22, v112, v114
    v_cvt_pk_bf16_f32 v38, v113, v115
    v_pk_fma_f32 v[116:117], s[64:65], v[114:115], v[116:117] op_sel:[0,0,0] op_sel_hi:[0,1,1]
    v_pk_fma_f32 v[116:117], s[64:65], v[114:115], v[116:117] op_sel:[1,1,0] op_sel_hi:[1,0,1] neg_lo:[1,0,0]
    v_pk_fma_f32 v[118:119], s[64:65], v[116:117], v[118:119] op_sel:[0,0,0] op_sel_hi:[0,1,1]
    v_pk_fma_f32 v[118:119], s[64:65], v[116:117], v[118:119] op_sel:[1,1,0] op_sel_hi:[1,0,1] neg_lo:[1,0,0]
    v_cvt_pk_bf16_f32 v23, v116, v118
    v_cvt_pk_bf16_f32 v39, v117, v119
    buffer_store_dwordx4 v[8:11], v3, s[20:23], s47 offen offset:0
    buffer_store_dwordx4 v[12:15], v3, s[20:23], s47 offen offset:16
    buffer_store_dwordx4 v[16:19], v3, s[20:23], s47 offen offset:32
    buffer_store_dwordx4 v[20:23], v3, s[20:23], s47 offen offset:48
    buffer_store_dwordx4 v[24:27], v3, s[20:23], s48 offen offset:0
    buffer_store_dwordx4 v[28:31], v3, s[20:23], s48 offen offset:16
    buffer_store_dwordx4 v[32:35], v3, s[20:23], s48 offen offset:32
    buffer_store_dwordx4 v[36:39], v3, s[20:23], s48 offen offset:48
    s_nop 1
    s_branch L_k2_wb
L_k2_noscan:
    s_cmp_eq_u32 s9, 0
    s_cbranch_scc1 L_k2_noprep
    s_nop 7
    s_load_dwordx4 s[44:47], s[0:1], 40
    s_load_dwordx2 s[48:49], s[0:1], 88
    s_sub_u32 s50, s2, 144
    s_lshl_b32 s51, s50, 8
    s_lshl_b32 s52, s3, 6
    s_add_u32 s51, s51, s52
    v_add_u32 v8, s51, v2
    s_mov_b32 s53, 58255
    v_mul_lo_u32 v10, v8, s53
    v_lshrrev_b32 v10, 22, v10
    v_mul_u32_u24 v11, 72, v10
    v_sub_u32 v11, v8, v11
    v_mul_u32_u24 v12, 1152, v10
    v_lshl_add_u32 v16, v11, 4, v12
    v_lshlrev_b32 v18, 6, v11
    v_mul_u32_u24 v12, 43, v11
    v_lshrrev_b32 v12, 9, v12
    v_mul_u32_u24 v13, 12, v12
    v_sub_u32 v13, v11, v13
    v_mul_u32_u24 v12, 24, v12
    v_add_u32 v12, v12, v13
    v_lshrrev_b32 v13, 1, v12
    v_and_b32 v12, 1, v12
    v_lshrrev_b32 v14, 5, v10
    v_mul_u32_u24 v14, 72, v14
    v_add_u32 v14, v14, v13
    v_lshlrev_b32 v14, 10, v14
    v_lshl_add_u32 v14, v12, 9, v14
    v_and_b32 v15, 31, v10
    v_lshl_add_u32 v14, v15, 4, v14
    v_cmp_gt_u32 vcc, 576, v10
    v_mov_b32 v15, 0x7f000000
    s_nop 0
    v_cndmask_b32 v20, v15, v14, vcc
    v_add_u32 v9, 28672, v8
    v_mul_lo_u32 v10, v9, s53
    v_lshrrev_b32 v10, 22, v10
    v_mul_u32_u24 v11, 72, v10
    v_sub_u32 v11, v9, v11
    v_mul_u32_u24 v12, 1152, v10
    v_lshl_add_u32 v17, v11, 4, v12
    v_lshlrev_b32 v19, 6, v11
    v_mul_u32_u24 v12, 43, v11
    v_lshrrev_b32 v12, 9, v12
    v_mul_u32_u24 v13, 12, v12
    v_sub_u32 v13, v11, v13
    v_mul_u32_u24 v12, 24, v12
    v_add_u32 v12, v12, v13
    v_lshrrev_b32 v13, 1, v12
    v_and_b32 v12, 1, v12
    v_lshrrev_b32 v14, 5, v10
    v_mul_u32_u24 v14, 72, v14
    v_add_u32 v14, v14, v13
    v_lshlrev_b32 v14, 10, v14
    v_lshl_add_u32 v14, v12, 9, v14
    v_and_b32 v15, 31, v10
    v_lshl_add_u32 v14, v15, 4, v14
    v_cmp_gt_u32 vcc, 576, v10
    v_mov_b32 v15, 0x7f000000
    s_nop 0
    v_cndmask_b32 v21, v15, v14, vcc
    s_waitcnt lgkmcnt(0)
    s_mov_b32 s56, s44
    s_and_b32 s57, s45, 0xffff
    s_mov_b32 s58, 663552
    s_mov_b32 s59, 0x20000
    s_mov_b32 s60, s46
    s_and_b32 s61, s47, 0xffff
    s_mov_b32 s62, 663552
    s_mov_b32 s63, 0x20000
    s_mov_b32 s64, s48
    s_and_b32 s65, s49, 0xffff
    s_mov_b32 s66, 663552
    s_mov_b32 s67, 0x20000
    s_mov_b32 s54, 16581632
    buffer_load_dwordx4 v[56:59], v16, s[56:59], 0 offen
    buffer_load_dwordx4 v[60:63], v16, s[60:63], 0 offen
    buffer_load_dwordx4 v[64:67], v18, s[20:23], s54 offen offset:0
    buffer_load_dwordx4 v[68:71], v18, s[20:23], s54 offen offset:16
    buffer_load_dwordx4 v[72:75], v18, s[20:23], s54 offen offset:32
    buffer_load_dwordx4 v[76:79], v18, s[20:23], s54 offen offset:48
    buffer_load_dwordx4 v[80:83], v17, s[56:59], 0 offen
    buffer_load_dwordx4 v[84:87], v17, s[60:63], 0 offen
    buffer_load_dwordx4 v[88:91], v19, s[20:23], s54 offen offset:0
    buffer_load_dwordx4 v[92:95], v19, s[20:23], s54 offen offset:16
    buffer_load_dwordx4 v[96:99], v19, s[20:23], s54 offen offset:32
    buffer_load_dwordx4 v[100:103], v19, s[20:23], s54 offen offset:48
    v_and_b32 v22, 31, v2
    v_lshrrev_b32 v23, 5, v2
    s_lshl_b32 s51, s50, 2
    s_add_u32 s51, s51, s3
    s_add_u32 s68, s51, 0
    s_min_u32 s68, s68, 647
    s_mul_i32 s52, s68, 911
    s_lshr_b32 s52, s52, 15
    s_mul_i32 s53, s52, 36
    s_sub_u32 s53, s68, s53
    s_sub_u32 s55, s53, 32
    s_mul_i32 s55, s55, 144
    s_add_u32 s55, s55, 16
    s_mul_i32 s70, s53, 18
    s_cmp_ge_u32 s53, 32
    s_cselect_b32 s55, s55, s70
    s_cselect_b32 s70, 72, 4
    s_cselect_b32 s71, 1, 0
    v_mul_u32_u24 v24, s70, v23
    v_add_u32 v24, s55, v24
    v_mul_u32_u24 v24, 1152, v24
    s_lshl_b32 s52, s52, 6
    v_lshl_add_u32 v24, v22, 1, v24
    v_add_u32 v26, s52, v24
    s_mov_b32 s55, 0
    buffer_load_ushort v104, v26, s[64:67], s55 offen
    s_mov_b32 s55, 1152
    buffer_load_ushort v105, v26, s[64:67], s55 offen
    s_cmp_eq_u32 s71, 0
    s_mov_b32 s55, 20736
    s_cselect_b32 s55, 2304, s55
    buffer_load_ushort v106, v26, s[64:67], s55 offen
    s_cmp_eq_u32 s71, 0
    s_mov_b32 s55, 21888
    s_cselect_b32 s55, 3456, s55
    buffer_load_ushort v107, v26, s[64:67], s55 offen
    s_cmp_eq_u32 s71, 0
    s_mov_b32 s55, 41472
    s_cselect_b32 s55, 9216, s55
    buffer_load_ushort v108, v26, s[64:67], s55 offen
    s_cmp_eq_u32 s71, 0
    s_mov_b32 s55, 42624
    s_cselect_b32 s55, 10368, s55
    buffer_load_ushort v109, v26, s[64:67], s55 offen
    s_cmp_eq_u32 s71, 0
    s_mov_b32 s55, 62208
    s_cselect_b32 s55, 11520, s55
    buffer_load_ushort v110, v26, s[64:67], s55 offen
    s_cmp_eq_u32 s71, 0
    s_mov_b32 s55, 63360
    s_cselect_b32 s55, 12672, s55
    buffer_load_ushort v111, v26, s[64:67], s55 offen
    s_add_u32 s69, s51, 448
    s_min_u32 s69, s69, 647
    s_mul_i32 s52, s69, 911
    s_lshr_b32 s52, s52, 15
    s_mul_i32 s53, s52, 36
    s_sub_u32 s53, s69, s53
    s_sub_u32 s55, s53, 32
    s_mul_i32 s55, s55, 144
    s_add_u32 s55, s55, 16
    s_mul_i32 s70, s53, 18
    s_cmp_ge_u32 s53, 32
    s_cselect_b32 s55, s55, s70
    s_cselect_b32 s70, 72, 4
    s_cselect_b32 s71, 1, 0
    v_mul_u32_u24 v24, s70, v23
    v_add_u32 v24, s55, v24
    v_mul_u32_u24 v24, 1152, v24
    s_lshl_b32 s52, s52, 6
    v_lshl_add_u32 v24, v22, 1, v24
    v_add_u32 v27, s52, v24
    s_mov_b32 s55, 0
    buffer_load_ushort v112, v27, s[64:67], s55 offen
    s_mov_b32 s55, 1152
    buffer_load_ushort v113, v27, s[64:67], s55 offen
    s_cmp_eq_u32 s71, 0
    s_mov_b32 s55, 20736
    s_cselect_b32 s55, 2304, s55
    buffer_load_ushort v114, v27, s[64:67], s55 offen
    s_cmp_eq_u32 s71, 0
    s_mov_b32 s55, 21888
    s_cselect_b32 s55, 3456, s55
    buffer_load_ushort v115, v27, s[64:67], s55 offen
    s_cmp_eq_u32 s71, 0
    s_mov_b32 s55, 41472
    s_cselect_b32 s55, 9216, s55
    buffer_load_ushort v116, v27, s[64:67], s55 offen
    s_cmp_eq_u32 s71, 0
    s_mov_b32 s55, 42624
    s_cselect_b32 s55, 10368, s55
    buffer_load_ushort v117, v27, s[64:67], s55 offen
    s_cmp_eq_u32 s71, 0
    s_mov_b32 s55, 62208
    s_cselect_b32 s55, 11520, s55
    buffer_load_ushort v118, v27, s[64:67], s55 offen
    s_cmp_eq_u32 s71, 0
    s_mov_b32 s55, 63360
    s_cselect_b32 s55, 12672, s55
    buffer_load_ushort v119, v27, s[64:67], s55 offen
    s_mov_b32 s52, 14286848
    s_mov_b32 s53, 14292992
    s_waitcnt vmcnt(22)
    v_lshlrev_b32 v8, 16, v56
    v_lshlrev_b32 v9, 16, v60
    v_mul_f32 v28, v8, v64
    v_mul_f32 v64, v9, v64
    v_fma_f32 v28, -v9, v65, v28
    v_fma_f32 v65, v8, v65, v64
    v_and_b32 v8, 0xffff0000, v56
    v_and_b32 v9, 0xffff0000, v60
    v_mul_f32 v29, v8, v66
    v_mul_f32 v66, v9, v66
    v_fma_f32 v29, -v9, v67, v29
    v_fma_f32 v67, v8, v67, v66
    v_lshlrev_b32 v8, 16, v57
    v_lshlrev_b32 v9, 16, v61
    v_mul_f32 v30, v8, v68
    v_mul_f32 v68, v9, v68
    v_fma_f32 v30, -v9, v69, v30
    v_fma_f32 v69, v8, v69, v68
    v_and_b32 v8, 0xffff0000, v57
    v_and_b32 v9, 0xffff0000, v61
    v_mul_f32 v31, v8, v70
    v_mul_f32 v70, v9, v70
    v_fma_f32 v31, -v9, v71, v31
    v_fma_f32 v71, v8, v71, v70
    v_lshlrev_b32 v8, 16, v58
    v_lshlrev_b32 v9, 16, v62
    v_mul_f32 v32, v8, v72
    v_mul_f32 v72, v9, v72
    v_fma_f32 v32, -v9, v73, v32
    v_fma_f32 v73, v8, v73, v72
    v_and_b32 v8, 0xffff0000, v58
    v_and_b32 v9, 0xffff0000, v62
    v_mul_f32 v33, v8, v74
    v_mul_f32 v74, v9, v74
    v_fma_f32 v33, -v9, v75, v33
    v_fma_f32 v75, v8, v75, v74
    v_lshlrev_b32 v8, 16, v59
    v_lshlrev_b32 v9, 16, v63
    v_mul_f32 v34, v8, v76
    v_mul_f32 v76, v9, v76
    v_fma_f32 v34, -v9, v77, v34
    v_fma_f32 v77, v8, v77, v76
    v_and_b32 v8, 0xffff0000, v59
    v_and_b32 v9, 0xffff0000, v63
    v_mul_f32 v35, v8, v78
    v_mul_f32 v78, v9, v78
    v_fma_f32 v35, -v9, v79, v35
    v_fma_f32 v79, v8, v79, v78
    v_cvt_pk_bf16_f32 v8, v28, v29
    v_cvt_pk_bf16_f32 v12, -v65, -v67
    v_cvt_pk_bf16_f32 v9, v30, v31
    v_cvt_pk_bf16_f32 v13, -v69, -v71
    v_cvt_pk_bf16_f32 v10, v32, v33
    v_cvt_pk_bf16_f32 v14, -v73, -v75
    v_cvt_pk_bf16_f32 v11, v34, v35
    v_cvt_pk_bf16_f32 v15, -v77, -v79
    buffer_store_dwordx4 v[8:11], v20, s[20:23], s52 offen
    buffer_store_dwordx4 v[12:15], v20, s[20:23], s53 offen
    s_nop 1
    s_waitcnt vmcnt(18)
    v_lshlrev_b32 v8, 16, v80
    v_lshlrev_b32 v9, 16, v84
    v_mul_f32 v28, v8, v88
    v_mul_f32 v88, v9, v88
    v_fma_f32 v28, -v9, v89, v28
    v_fma_f32 v89, v8, v89, v88
    v_and_b32 v8, 0xffff0000, v80
    v_and_b32 v9, 0xffff0000, v84
    v_mul_f32 v29, v8, v90
    v_mul_f32 v90, v9, v90
    v_fma_f32 v29, -v9, v91, v29
    v_fma_f32 v91, v8, v91, v90
    v_lshlrev_b32 v8, 16, v81
    v_lshlrev_b32 v9, 16, v85
    v_mul_f32 v30, v8, v92
    v_mul_f32 v92, v9, v92
    v_fma_f32 v30, -v9, v93, v30
    v_fma_f32 v93, v8, v93, v92
    v_and_b32 v8, 0xffff0000, v81
    v_and_b32 v9, 0xffff0000, v85
    v_mul_f32 v31, v8, v94
    v_mul_f32 v94, v9, v94
    v_fma_f32 v31, -v9, v95, v31
    v_fma_f32 v95, v8, v95, v94
    v_lshlrev_b32 v8, 16, v82
    v_lshlrev_b32 v9, 16, v86
    v_mul_f32 v32, v8, v96
    v_mul_f32 v96, v9, v96
    v_fma_f32 v32, -v9, v97, v32
    v_fma_f32 v97, v8, v97, v96
    v_and_b32 v8, 0xffff0000, v82
    v_and_b32 v9, 0xffff0000, v86
    v_mul_f32 v33, v8, v98
    v_mul_f32 v98, v9, v98
    v_fma_f32 v33, -v9, v99, v33
    v_fma_f32 v99, v8, v99, v98
    v_lshlrev_b32 v8, 16, v83
    v_lshlrev_b32 v9, 16, v87
    v_mul_f32 v34, v8, v100
    v_mul_f32 v100, v9, v100
    v_fma_f32 v34, -v9, v101, v34
    v_fma_f32 v101, v8, v101, v100
    v_and_b32 v8, 0xffff0000, v83
    v_and_b32 v9, 0xffff0000, v87
    v_mul_f32 v35, v8, v102
    v_mul_f32 v102, v9, v102
    v_fma_f32 v35, -v9, v103, v35
    v_fma_f32 v103, v8, v103, v102
    v_cvt_pk_bf16_f32 v8, v28, v29
    v_cvt_pk_bf16_f32 v12, -v89, -v91
    v_cvt_pk_bf16_f32 v9, v30, v31
    v_cvt_pk_bf16_f32 v13, -v93, -v95
    v_cvt_pk_bf16_f32 v10, v32, v33
    v_cvt_pk_bf16_f32 v14, -v97, -v99
    v_cvt_pk_bf16_f32 v11, v34, v35
    v_cvt_pk_bf16_f32 v15, -v101, -v103
    buffer_store_dwordx4 v[8:11], v21, s[20:23], s52 offen
    buffer_store_dwordx4 v[12:15], v21, s[20:23], s53 offen
    s_nop 1
    s_waitcnt vmcnt(4)
    v_lshl_or_b32 v28, v105, 16, v104
    v_lshl_or_b32 v29, v107, 16, v106
    v_lshl_or_b32 v30, v109, 16, v108
    v_lshl_or_b32 v31, v111, 16, v110
    s_lshl_b32 s52, s68, 10
    s_add_u32 s52, s52, 15613952
    buffer_store_dwordx4 v[28:31], v7, s[20:23], s52 offen
    v_lshl_or_b32 v32, v113, 16, v112
    v_lshl_or_b32 v33, v115, 16, v114
    v_lshl_or_b32 v34, v117, 16, v116
    v_lshl_or_b32 v35, v119, 16, v118
    s_lshl_b32 s52, s69, 10
    s_add_u32 s52, s52, 15613952
    buffer_store_dwordx4 v[32:35], v7, s[20:23], s52 offen
    s_nop 1
L_k2_wb:
    s_cmp_lg_u32 s3, 0
    s_cbranch_scc1 L_k2_noprep
    s_cmp_ge_u32 s2, 8
    s_cbranch_scc1 L_k2_noprep
    s_waitcnt vmcnt(0)
    buffer_wbl2 sc1
L_k2_noprep:
    s_setprio 0
    s_barrier
    s_mul_i32 s30, s24, 3072
    v_mul_u32_u24 v3, 48, v2
    v_add_u32 v3, s30, v3
    s_nop 7
    s_cmp_eq_u32 s25, 0
    s_cbranch_scc1 L_k2_e1
    ds_write_b128 v3, v[40:43] offset:0
    ds_write_b128 v3, v[44:47] offset:16
    ds_write_b128 v3, v[48:51] offset:32
    s_waitcnt lgkmcnt(0)
L_k2_e1:
    s_barrier
    s_cmp_eq_u32 s25, 0
    s_cbranch_scc0 L_k2_e2
    ds_read_b128 v[56:59], v3 offset:0
    ds_read_b128 v[60:63], v3 offset:16
    ds_read_b128 v[64:67], v3 offset:32
    s_waitcnt lgkmcnt(0)
    v_add_f32 v40, v40, v56
    v_add_f32 v41, v41, v57
    v_add_f32 v42, v42, v58
    v_add_f32 v43, v43, v59
    v_add_f32 v44, v44, v60
    v_add_f32 v45, v45, v61
    v_add_f32 v46, v46, v62
    v_add_f32 v47, v47, v63
    v_add_f32 v48, v48, v64
    v_add_f32 v49, v49, v65
    v_add_f32 v50, v50, v66
    v_add_f32 v51, v51, v67
    v_mov_b32 v4, v50
    v_mov_b32 v5, v50
    s_nop 1
    v_permlane32_swap_b32 v4, v5
    s_nop 1
    v_rcp_f32 v5, v4
    s_nop 0
    v_mul_f32 v40, v40, v5
    v_mul_f32 v41, v41, v5
    v_mul_f32 v42, v42, v5
    v_mul_f32 v43, v43, v5
    v_mul_f32 v44, v44, v5
    v_mul_f32 v45, v45, v5
    v_mul_f32 v46, v46, v5
    v_mul_f32 v47, v47, v5
    v_mul_f32 v48, v48, v5
    v_mul_f32 v49, v49, v5
    v_cvt_pk_bf16_f32 v56, v40, v41
    v_cvt_pk_bf16_f32 v57, v42, v43
    v_cvt_pk_bf16_f32 v58, v44, v45
    v_cvt_pk_bf16_f32 v59, v46, v47
    v_cvt_pk_bf16_f32 v60, v48, v49
    s_lshl_b32 s30, s5, 3
    s_add_u32 s30, s30, s24
    s_lshl_b32 s31, s4, 6
    s_add_u32 s31, s31, s30
    s_lshl_b32 s31, s31, 10
    s_add_u32 s31, s31, 11927552
    buffer_store_dwordx4 v[56:59], v7, s[20:23], s31 offen
    s_lshr_b32 s31, s4, 3
    s_lshl_b32 s31, s31, 6
    s_add_u32 s31, s31, s30
    s_lshl_b32 s31, s31, 10
    s_bfe_u32 s32, s4, 0x10002
    s_lshl_b32 s32, s32, 9
    s_add_u32 s31, s31, s32
    s_and_b32 s32, s4, 3
    s_lshl_b32 s32, s32, 2
    s_add_u32 s31, s31, s32
    s_add_u32 s31, s31, 14024704
    v_cmp_gt_u32 vcc, 32, v2
    s_and_saveexec_b64 s[34:35], vcc
    buffer_store_dword v60, v7, s[20:23], s31 offen
    s_mov_b64 exec, s[34:35]
    s_cmp_lg_u32 s6, 0
    s_cbranch_scc1 L_k2_e2
    s_mov_b32 s31, 0x17800000
    s_mov_b32 s32, 0x5d800000
    v_cmp_nle_f32 vcc, s31, v4
    s_mov_b64 s[34:35], vcc
    v_cmp_nge_f32 vcc, s32, v4
    s_or_b64 s[34:35], s[34:35], vcc
    s_movk_i32 s33, 0x207
    v_cmp_class_f32 vcc, v40, s33
    s_or_b64 s[34:35], s[34:35], vcc
    v_cmp_class_f32 vcc, v41, s33
    s_or_b64 s[34:35], s[34:35], vcc
    v_cmp_class_f32 vcc, v42, s33
    s_or_b64 s[34:35], s[34:35], vcc
    v_cmp_class_f32 vcc, v43, s33
    s_or_b64 s[34:35], s[34:35], vcc
    v_cmp_class_f32 vcc, v44, s33
    s_or_b64 s[34:35], s[34:35], vcc
    v_cmp_class_f32 vcc, v45, s33
    s_or_b64 s[34:35], s[34:35], vcc
    v_cmp_class_f32 vcc, v46, s33
    s_or_b64 s[34:35], s[34:35], vcc
    v_cmp_class_f32 vcc, v47, s33
    s_or_b64 s[34:35], s[34:35], vcc
    v_cmp_class_f32 vcc, v48, s33
    s_or_b32 s34, s34, vcc_lo
    v_cmp_class_f32 vcc, v49, s33
    s_or_b32 s34, s34, vcc_lo
    s_cmp_eq_u64 s[34:35], 0
    s_cbranch_scc1 L_k2_e2
    v_mov_b32 v6, 160768
    v_mov_b32 v5, 1
    ds_write_b32 v6, v5
    s_waitcnt lgkmcnt(0)
L_k2_e2:
    s_barrier
    s_cmp_lg_u32 s6, 0
    s_cbranch_scc1 L_k2_fin
    v_mov_b32 v6, 160768
    ds_read_b32 v5, v6
    s_waitcnt lgkmcnt(0)
    v_readfirstlane_b32 s33, v5
    s_nop 3
    s_cmp_eq_u32 s33, 0
    s_cbranch_scc1 L_k2_fin
    s_mov_b32 s6, 1
    s_mov_b32 s8, 0
    s_mov_b32 s9, 0
    s_waitcnt vmcnt(0)
    s_branch L_k2_dma
L_k2_fin:
L_k2_end:
    s_endpgm
L_k2_codeend:
.section .rodata,"a"
.p2align 6
.amdhsa_kernel s5mha_k2_kernel
  .amdhsa_next_free_vgpr 128
  .amdhsa_next_free_sgpr 96
  .amdhsa_accum_offset 128
  .amdhsa_group_segment_fixed_size 0
  .amdhsa_kernarg_size 120
  .amdhsa_user_sgpr_count 2
  .amdhsa_user_sgpr_kernarg_segment_ptr 1
  .amdhsa_system_sgpr_workgroup_id_x 1
  .amdhsa_float_denorm_mode_32 3
.end_amdhsa_kernel

.text
.globl s5mha_k3_kernel
.p2align 8
.type s5mha_k3_kernel,@function
s5mha_k3_kernel:

    s_cmp_ge_u32 s2, 256
    s_cbranch_scc1 L_k3_end
    s_load_dwordx2 s[40:41], s[0:1], 112
    s_load_dwordx2 s[42:43], s[0:1], 96
    s_load_dwordx2 s[46:47], s[0:1], 0
    s_load_dwordx2 s[48:49], s[0:1], 64
    v_lshrrev_b32 v1, 6, v0
    v_and_b32 v2, 63, v0
    s_and_b32 s7, s2, 7
    v_readfirstlane_b32 s3, v1
    s_lshr_b32 s35, s2, 3
    v_lshlrev_b32 v8, 4, v2
    s_cmp_lg_u32 s3, 1
    s_cbranch_scc1 L_k3_nocpf
    s_getpc_b64 s[76:77]
L_cpf_k3:
    s_add_u32 s76, s76, s5mha_k3_kernel-L_cpf_k3
    s_addc_u32 s77, s77, ((s5mha_k3_kernel-L_cpf_k3)>>32)
    v_lshlrev_b32 v138, 7, v2
    v_min_u32 v138, L_k3_codeend-s5mha_k3_kernel-4, v138
    global_load_dword v139, v138, s[76:77]
    v_lshlrev_b32 v138, 7, v2
    v_add_u32 v138, 8192, v138
    v_min_u32 v138, L_k3_codeend-s5mha_k3_kernel-4, v138
    global_load_dword v139, v138, s[76:77]
L_k3_nocpf:
    s_mul_i32 s36, s7, 24
    s_add_u32 s36, s36, s35
    s_lshl_b32 s37, s7, 3
    s_add_u32 s37, s37, s35
    s_add_u32 s37, s37, 168
    s_cmp_ge_u32 s35, 24
    s_cselect_b32 s35, s37, s36
    s_cbranch_scc0 L_k3_y
L_k3_b:
    s_sub_u32 s35, s35, 192
    s_lshr_b32 s5, s35, 2
    s_and_b32 s6, s35, 3
    s_cmp_ge_u32 s3, 8
    s_cbranch_scc1 L_k3_end
    s_cmp_ge_u32 s3, 4
    s_cbranch_scc0 L_k3_bcons
L_k3_bprod:
    s_sub_u32 s36, s3, 4
    s_lshl_b32 s37, s5, 2
    s_lshl_b32 s38, s36, 6
    s_add_u32 s37, s37, s38
    s_lshl_b32 s50, s37, 10
    s_add_u32 s50, s50, 11927552
    s_lshl_b32 s51, s36, 12
    s_mul_i32 s52, s6, 5
    s_mul_i32 s38, s36, 5
    s_add_u32 s38, s38, 0
    s_lshr_b32 s39, s38, 2
    s_and_b32 s53, s38, 3
    s_add_u32 s39, s39, s52
    s_min_u32 s39, s39, 17
    s_mul_i32 s39, s39, 36
    s_add_u32 s39, s39, s53
    s_lshl_b32 s39, s39, 10
    s_add_u32 s60, s39, 15613952
    s_lshl_b32 s38, s38, 10
    s_add_u32 s65, s38, 16384
    s_mul_i32 s38, s36, 5
    s_add_u32 s38, s38, 1
    s_lshr_b32 s39, s38, 2
    s_and_b32 s53, s38, 3
    s_add_u32 s39, s39, s52
    s_min_u32 s39, s39, 17
    s_mul_i32 s39, s39, 36
    s_add_u32 s39, s39, s53
    s_lshl_b32 s39, s39, 10
    s_add_u32 s61, s39, 15613952
    s_lshl_b32 s38, s38, 10
    s_add_u32 s66, s38, 16384
    s_mul_i32 s38, s36, 5
    s_add_u32 s38, s38, 2
    s_lshr_b32 s39, s38, 2
    s_and_b32 s53, s38, 3
    s_add_u32 s39, s39, s52
    s_min_u32 s39, s39, 17
    s_mul_i32 s39, s39, 36
    s_add_u32 s39, s39, s53
    s_lshl_b32 s39, s39, 10
    s_add_u32 s62, s39, 15613952
    s_lshl_b32 s38, s38, 10
    s_add_u32 s67, s38, 16384
    s_mul_i32 s38, s36, 5
    s_add_u32 s38, s38, 3
    s_lshr_b32 s39, s38, 2
    s_and_b32 s53, s38, 3
    s_add_u32 s39, s39, s52
    s_min_u32 s39, s39, 17
    s_mul_i32 s39, s39, 36
    s_add_u32 s39, s39, s53
    s_lshl_b32 s39, s39, 10
    s_add_u32 s63, s39, 15613952
    s_lshl_b32 s38, s38, 10
    s_add_u32 s68, s38, 16384
    s_mul_i32 s38, s36, 5
    s_add_u32 s38, s38, 4
    s_lshr_b32 s39, s38, 2
    s_and_b32 s53, s38, 3
    s_add_u32 s39, s39, s52
    s_min_u32 s39, s39, 17
    s_mul_i32 s39, s39, 36
    s_add_u32 s39, s39, s53
    s_lshl_b32 s39, s39, 10
    s_add_u32 s64, s39, 15613952
    s_lshl_b32 s38, s38, 10
    s_add_u32 s69, s38, 16384
    s_mov_b32 s57, 0
    s_waitcnt lgkmcnt(0)
    s_mov_b32 s20, s40
    s_and_b32 s21, s41, 0xffff
    s_mov_b32 s22, 16586240
    s_mov_b32 s23, 0x20000
    s_add_u32 s58, s51, s57
    s_add_u32 m0, s58, 0
    s_add_u32 s59, s50, 0
    buffer_load_dwordx4 v8, s[20:23], s59 offen lds
    s_add_u32 m0, s58, 1024
    s_add_u32 s59, s50, 1024
    buffer_load_dwordx4 v8, s[20:23], s59 offen lds
    s_add_u32 m0, s58, 2048
    s_add_u32 s59, s50, 2048
    buffer_load_dwordx4 v8, s[20:23], s59 offen lds
    s_add_u32 m0, s58, 3072
    s_add_u32 s59, s50, 3072
    buffer_load_dwordx4 v8, s[20:23], s59 offen lds
    s_add_u32 m0, s65, s57
    s_nop 0
    buffer_load_dwordx4 v8, s[20:23], s60 offen lds
    s_add_u32 s60, s60, 4096
    s_add_u32 m0, s66, s57
    s_nop 0
    buffer_load_dwordx4 v8, s[20:23], s61 offen lds
    s_add_u32 s61, s61, 4096
    s_add_u32 m0, s67, s57
    s_nop 0
    buffer_load_dwordx4 v8, s[20:23], s62 offen lds
    s_add_u32 s62, s62, 4096
    s_add_u32 m0, s68, s57
    s_nop 0
    buffer_load_dwordx4 v8, s[20:23], s63 offen lds
    s_add_u32 s63, s63, 4096
    s_add_u32 m0, s69, s57
    s_nop 0
    buffer_load_dwordx4 v8, s[20:23], s64 offen lds
    s_add_u32 s64, s64, 4096
    s_add_u32 s50, s50, 262144
    s_add_u32 s57, s57, 40960
    s_cmp_eq_u32 s57, 163840
    s_cselect_b32 s57, 0, s57
    s_add_u32 s58, s51, s57
    s_add_u32 m0, s58, 0
    s_add_u32 s59, s50, 0
    buffer_load_dwordx4 v8, s[20:23], s59 offen lds
    s_add_u32 m0, s58, 1024
    s_add_u32 s59, s50, 1024
    buffer_load_dwordx4 v8, s[20:23], s59 offen lds
    s_add_u32 m0, s58, 2048
    s_add_u32 s59, s50, 2048
    buffer_load_dwordx4 v8, s[20:23], s59 offen lds
    s_add_u32 m0, s58, 3072
    s_add_u32 s59, s50, 3072
    buffer_load_dwordx4 v8, s[20:23], s59 offen lds
    s_add_u32 m0, s65, s57
    s_nop 0
    buffer_load_dwordx4 v8, s[20:23], s60 offen lds
    s_add_u32 s60, s60, 4096
    s_add_u32 m0, s66, s57
    s_nop 0
    buffer_load_dwordx4 v8, s[20:23], s61 offen lds
    s_add_u32 s61, s61, 4096
    s_add_u32 m0, s67, s57
    s_nop 0
    buffer_load_dwordx4 v8, s[20:23], s62 offen lds
    s_add_u32 s62, s62, 4096
    s_add_u32 m0, s68, s57
    s_nop 0
    buffer_load_dwordx4 v8, s[20:23], s63 offen lds
    s_add_u32 s63, s63, 4096
    s_add_u32 m0, s69, s57
    s_nop 0
    buffer_load_dwordx4 v8, s[20:23], s64 offen lds
    s_add_u32 s64, s64, 4096
    s_add_u32 s50, s50, 262144
    s_add_u32 s57, s57, 40960
    s_cmp_eq_u32 s57, 163840
    s_cselect_b32 s57, 0, s57
    s_waitcnt vmcnt(9)
    s_barrier
    s_add_u32 s58, s51, s57
    s_add_u32 m0, s58, 0
    s_add_u32 s59, s50, 0
    buffer_load_dwordx4 v8, s[20:23], s59 offen lds
    s_add_u32 m0, s58, 1024
    s_add_u32 s59, s50, 1024
    buffer_load_dwordx4 v8, s[20:23], s59 offen lds
    s_add_u32 m0, s58, 2048
    s_add_u32 s59, s50, 2048
    buffer_load_dwordx4 v8, s[20:23], s59 offen lds
    s_add_u32 m0, s58, 3072
    s_add_u32 s59, s50, 3072
    buffer_load_dwordx4 v8, s[20:23], s59 offen lds
    s_add_u32 m0, s65, s57
    s_nop 0
    buffer_load_dwordx4 v8, s[20:23], s60 offen lds
    s_add_u32 s60, s60, 4096
    s_add_u32 m0, s66, s57
    s_nop 0
    buffer_load_dwordx4 v8, s[20:23], s61 offen lds
    s_add_u32 s61, s61, 4096
    s_add_u32 m0, s67, s57
    s_nop 0
    buffer_load_dwordx4 v8, s[20:23], s62 offen lds
    s_add_u32 s62, s62, 4096
    s_add_u32 m0, s68, s57
    s_nop 0
    buffer_load_dwordx4 v8, s[20:23], s63 offen lds
    s_add_u32 s63, s63, 4096
    s_add_u32 m0, s69, s57
    s_nop 0
    buffer_load_dwordx4 v8, s[20:23], s64 offen lds
    s_add_u32 s64, s64, 4096
    s_add_u32 s50, s50, 262144
    s_add_u32 s57, s57, 40960
    s_cmp_eq_u32 s57, 163840
    s_cselect_b32 s57, 0, s57
    s_mov_b32 s56, 6
L_k3_bploop:
    s_waitcnt vmcnt(9)
    s_barrier
    s_add_u32 s58, s51, s57
    s_add_u32 m0, s58, 0
    s_add_u32 s59, s50, 0
    buffer_load_dwordx4 v8, s[20:23], s59 offen lds
    s_add_u32 m0, s58, 1024
    s_add_u32 s59, s50, 1024
    buffer_load_dwordx4 v8, s[20:23], s59 offen lds
    s_add_u32 m0, s58, 2048
    s_add_u32 s59, s50, 2048
    buffer_load_dwordx4 v8, s[20:23], s59 offen lds
    s_add_u32 m0, s58, 3072
    s_add_u32 s59, s50, 3072
    buffer_load_dwordx4 v8, s[20:23], s59 offen lds
    s_add_u32 m0, s65, s57
    s_nop 0
    buffer_load_dwordx4 v8, s[20:23], s60 offen lds
    s_add_u32 s60, s60, 4096
    s_add_u32 m0, s66, s57
    s_nop 0
    buffer_load_dwordx4 v8, s[20:23], s61 offen lds
    s_add_u32 s61, s61, 4096
    s_add_u32 m0, s67, s57
    s_nop 0
    buffer_load_dwordx4 v8, s[20:23], s62 offen lds
    s_add_u32 s62, s62, 4096
    s_add_u32 m0, s68, s57
    s_nop 0
    buffer_load_dwordx4 v8, s[20:23], s63 offen lds
    s_add_u32 s63, s63, 4096
    s_add_u32 m0, s69, s57
    s_nop 0
    buffer_load_dwordx4 v8, s[20:23], s64 offen lds
    s_add_u32 s64, s64, 4096
    s_add_u32 s50, s50, 262144
    s_add_u32 s57, s57, 40960
    s_cmp_eq_u32 s57, 163840
    s_cselect_b32 s57, 0, s57
    s_sub_u32 s56, s56, 1
    s_cmp_lg_u32 s56, 0
    s_cbranch_scc1 L_k3_bploop
    s_waitcnt vmcnt(9)
    s_barrier
    s_waitcnt vmcnt(0)
    s_barrier
    s_endpgm
L_k3_y:
    s_mul_i32 s5, s35, 10923
    s_lshr_b32 s5, s5, 16
    s_mul_i32 s36, s5, 6
    s_sub_u32 s6, s35, s36
    s_cmp_ge_u32 s3, 6
    s_cbranch_scc0 L_k3_ycons
L_k3_yprod:
    s_sub_u32 s36, s3, 6
    s_lshr_b32 s37, s36, 1
    s_and_b32 s38, s36, 1
    s_lshl_b32 s39, s5, 1
    s_add_u32 s39, s39, s37
    s_mul_i32 s50, s39, 73728
    s_lshl_b32 s39, s38, 12
    s_add_u32 s50, s50, s39
    s_add_u32 s50, s50, 7208960
    s_lshl_b32 s51, s36, 12
    s_mul_i32 s52, s6, 3
    s_mul_i32 s52, s52, 73728
    s_lshl_b32 s53, s36, 11
    s_add_u32 s52, s52, s53
    s_add_u32 s52, s52, 14286848
    s_add_u32 s53, s53, 16384
    s_mov_b32 s57, 0
    s_waitcnt lgkmcnt(0)
    s_mov_b32 s20, s40
    s_and_b32 s21, s41, 0xffff
    s_mov_b32 s22, 16586240
    s_mov_b32 s23, 0x20000
    s_add_u32 s58, s51, s57
    s_add_u32 m0, s58, 0
    s_add_u32 s59, s50, 0
    buffer_load_dwordx4 v8, s[20:23], s59 offen lds
    s_add_u32 m0, s58, 1024
    s_add_u32 s59, s50, 1024
    buffer_load_dwordx4 v8, s[20:23], s59 offen lds
    s_add_u32 m0, s58, 2048
    s_add_u32 s59, s50, 2048
    buffer_load_dwordx4 v8, s[20:23], s59 offen lds
    s_add_u32 m0, s58, 3072
    s_add_u32 s59, s50, 3072
    buffer_load_dwordx4 v8, s[20:23], s59 offen lds
    s_add_u32 s58, s53, s57
    s_add_u32 m0, s58, 0
    s_add_u32 s59, s52, 0
    buffer_load_dwordx4 v8, s[20:23], s59 offen lds
    s_add_u32 m0, s58, 1024
    s_add_u32 s59, s52, 1024
    buffer_load_dwordx4 v8, s[20:23], s59 offen lds
    s_add_u32 m0, s58, 8192
    s_add_u32 s59, s52, 73728
    buffer_load_dwordx4 v8, s[20:23], s59 offen lds
    s_add_u32 m0, s58, 9216
    s_add_u32 s59, s52, 74752
    buffer_load_dwordx4 v8, s[20:23], s59 offen lds
    s_add_u32 m0, s58, 16384
    s_add_u32 s59, s52, 147456
    buffer_load_dwordx4 v8, s[20:23], s59 offen lds
    s_add_u32 m0, s58, 17408
    s_add_u32 s59, s52, 148480
    buffer_load_dwordx4 v8, s[20:23], s59 offen lds
    s_add_u32 s50, s50, 8192
    s_add_u32 s52, s52, 8192
    s_add_u32 s57, s57, 40960
    s_cmp_eq_u32 s57, 163840
    s_cselect_b32 s57, 0, s57
    s_add_u32 s58, s51, s57
    s_add_u32 m0, s58, 0
    s_add_u32 s59, s50, 0
    buffer_load_dwordx4 v8, s[20:23], s59 offen lds
    s_add_u32 m0, s58, 1024
    s_add_u32 s59, s50, 1024
    buffer_load_dwordx4 v8, s[20:23], s59 offen lds
    s_add_u32 m0, s58, 2048
    s_add_u32 s59, s50, 2048
    buffer_load_dwordx4 v8, s[20:23], s59 offen lds
    s_add_u32 m0, s58, 3072
    s_add_u32 s59, s50, 3072
    buffer_load_dwordx4 v8, s[20:23], s59 offen lds
    s_add_u32 s58, s53, s57
    s_add_u32 m0, s58, 0
    s_add_u32 s59, s52, 0
    buffer_load_dwordx4 v8, s[20:23], s59 offen lds
    s_add_u32 m0, s58, 1024
    s_add_u32 s59, s52, 1024
    buffer_load_dwordx4 v8, s[20:23], s59 offen lds
    s_add_u32 m0, s58, 8192
    s_add_u32 s59, s52, 73728
    buffer_load_dwordx4 v8, s[20:23], s59 offen lds
    s_add_u32 m0, s58, 9216
    s_add_u32 s59, s52, 74752
    buffer_load_dwordx4 v8, s[20:23], s59 offen lds
    s_add_u32 m0, s58, 16384
    s_add_u32 s59, s52, 147456
    buffer_load_dwordx4 v8, s[20:23], s59 offen lds
    s_add_u32 m0, s58, 17408
    s_add_u32 s59, s52, 148480
    buffer_load_dwordx4 v8, s[20:23], s59 offen lds
    s_add_u32 s50, s50, 8192
    s_add_u32 s52, s52, 8192
    s_add_u32 s57, s57, 40960
    s_cmp_eq_u32 s57, 163840
    s_cselect_b32 s57, 0, s57
    s_waitcnt vmcnt(10)
    s_barrier
    s_add_u32 s58, s51, s57
    s_add_u32 m0, s58, 0
    s_add_u32 s59, s50, 0
    buffer_load_dwordx4 v8, s[20:23], s59 offen lds
    s_add_u32 m0, s58, 1024
    s_add_u32 s59, s50, 1024
    buffer_load_dwordx4 v8, s[20:23], s59 offen lds
    s_add_u32 m0, s58, 2048
    s_add_u32 s59, s50, 2048
    buffer_load_dwordx4 v8, s[20:23], s59 offen lds
    s_add_u32 m0, s58, 3072
    s_add_u32 s59, s50, 3072
    buffer_load_dwordx4 v8, s[20:23], s59 offen lds
    s_add_u32 s58, s53, s57
    s_add_u32 m0, s58, 0
    s_add_u32 s59, s52, 0
    buffer_load_dwordx4 v8, s[20:23], s59 offen lds
    s_add_u32 m0, s58, 1024
    s_add_u32 s59, s52, 1024
    buffer_load_dwordx4 v8, s[20:23], s59 offen lds
    s_add_u32 m0, s58, 8192
    s_add_u32 s59, s52, 73728
    buffer_load_dwordx4 v8, s[20:23], s59 offen lds
    s_add_u32 m0, s58, 9216
    s_add_u32 s59, s52, 74752
    buffer_load_dwordx4 v8, s[20:23], s59 offen lds
    s_add_u32 m0, s58, 16384
    s_add_u32 s59, s52, 147456
    buffer_load_dwordx4 v8, s[20:23], s59 offen lds
    s_add_u32 m0, s58, 17408
    s_add_u32 s59, s52, 148480
    buffer_load_dwordx4 v8, s[20:23], s59 offen lds
    s_add_u32 s50, s50, 8192
    s_add_u32 s52, s52, 8192
    s_add_u32 s57, s57, 40960
    s_cmp_eq_u32 s57, 163840
    s_cselect_b32 s57, 0, s57
    s_mov_b32 s56, 6
L_k3_yploop:
    s_waitcnt vmcnt(10)
    s_barrier
    s_add_u32 s58, s51, s57
    s_add_u32 m0, s58, 0
    s_add_u32 s59, s50, 0
    buffer_load_dwordx4 v8, s[20:23], s59 offen lds
    s_add_u32 m0, s58, 1024
    s_add_u32 s59, s50, 1024
    buffer_load_dwordx4 v8, s[20:23], s59 offen lds
    s_add_u32 m0, s58, 2048
    s_add_u32 s59, s50, 2048
    buffer_load_dwordx4 v8, s[20:23], s59 offen lds
    s_add_u32 m0, s58, 3072
    s_add_u32 s59, s50, 3072
    buffer_load_dwordx4 v8, s[20:23], s59 offen lds
    s_add_u32 s58, s53, s57
    s_add_u32 m0, s58, 0
    s_add_u32 s59, s52, 0
    buffer_load_dwordx4 v8, s[20:23], s59 offen lds
    s_add_u32 m0, s58, 1024
    s_add_u32 s59, s52, 1024
    buffer_load_dwordx4 v8, s[20:23], s59 offen lds
    s_add_u32 m0, s58, 8192
    s_add_u32 s59, s52, 73728
    buffer_load_dwordx4 v8, s[20:23], s59 offen lds
    s_add_u32 m0, s58, 9216
    s_add_u32 s59, s52, 74752
    buffer_load_dwordx4 v8, s[20:23], s59 offen lds
    s_add_u32 m0, s58, 16384
    s_add_u32 s59, s52, 147456
    buffer_load_dwordx4 v8, s[20:23], s59 offen lds
    s_add_u32 m0, s58, 17408
    s_add_u32 s59, s52, 148480
    buffer_load_dwordx4 v8, s[20:23], s59 offen lds
    s_add_u32 s50, s50, 8192
    s_add_u32 s52, s52, 8192
    s_add_u32 s57, s57, 40960
    s_cmp_eq_u32 s57, 163840
    s_cselect_b32 s57, 0, s57
    s_sub_u32 s56, s56, 1
    s_cmp_lg_u32 s56, 0
    s_cbranch_scc1 L_k3_yploop
    s_waitcnt vmcnt(10)
    s_barrier
    s_waitcnt vmcnt(0)
    s_barrier
    s_endpgm
L_k3_bcons:
    s_lshl_b32 s38, s3, 10
    v_add_u32 v128, s38, v8
    v_add_u32 v129, 16384, v8
    v_and_b32 v3, 31, v2
    v_lshrrev_b32 v4, 5, v2
    s_mul_i32 s39, s3, 20480
    s_add_u32 s39, s39, 40960
    v_and_b32 v5, 7, v3
    v_lshlrev_b32 v6, 7, v3
    v_add_u32 v6, s39, v6
    v_add_u32 v7, 0, v4
    v_xor_b32 v7, v7, v5
    v_lshl_add_u32 v133, v7, 4, v6
    v_add_u32 v7, 2, v4
    v_xor_b32 v7, v7, v5
    v_lshl_add_u32 v134, v7, 4, v6
    v_add_u32 v7, 4, v4
    v_xor_b32 v7, v7, v5
    v_lshl_add_u32 v135, v7, 4, v6
    v_add_u32 v7, 6, v4
    v_xor_b32 v7, v7, v5
    v_lshl_add_u32 v136, v7, 4, v6
    v_lshrrev_b32 v5, 3, v2
    v_and_b32 v6, 7, v2
    v_xor_b32 v7, v6, v5
    v_lshlrev_b32 v7, 4, v7
    v_lshl_add_u32 v7, v5, 7, v7
    v_add_u32 v131, s39, v7
    v_lshrrev_b32 v5, 3, v2
    v_mul_u32_u24 v5, 4608, v5
    v_and_b32 v6, 7, v2
    v_lshl_add_u32 v132, v6, 4, v5
    s_lshl_b32 s38, s5, 7
    s_lshl_b32 s39, s3, 5
    s_add_u32 s38, s38, s39
    s_mul_i32 s38, s38, 4608
    s_mul_i32 s39, s6, 640
    s_add_u32 s38, s38, s39
    s_add_u32 s38, s38, 2304
    v_mov_b32 v137, v2
    v_mov_b32 v0, 0
    v_mov_b32 v1, 0
    v_mov_b32 v2, 0
    v_mov_b32 v3, 0
    v_mov_b32 v4, 0
    v_mov_b32 v5, 0
    v_mov_b32 v6, 0
    v_mov_b32 v7, 0
    v_mov_b32 v8, 0
    v_mov_b32 v9, 0
    v_mov_b32 v10, 0
    v_mov_b32 v11, 0
    v_mov_b32 v12, 0
    v_mov_b32 v13, 0
    v_mov_b32 v14, 0
    v_mov_b32 v15, 0
    v_mov_b32 v16, 0
    v_mov_b32 v17, 0
    v_mov_b32 v18, 0
    v_mov_b32 v19, 0
    v_mov_b32 v20, 0
    v_mov_b32 v21, 0
    v_mov_b32 v22, 0
    v_mov_b32 v23, 0
    v_mov_b32 v24, 0
    v_mov_b32 v25, 0
    v_mov_b32 v26, 0
    v_mov_b32 v27, 0
    v_mov_b32 v28, 0
    v_mov_b32 v29, 0
    v_mov_b32 v30, 0
    v_mov_b32 v31, 0
    v_mov_b32 v32, 0
    v_mov_b32 v33, 0
    v_mov_b32 v34, 0
    v_mov_b32 v35, 0
    v_mov_b32 v36, 0
    v_mov_b32 v37, 0
    v_mov_b32 v38, 0
    v_mov_b32 v39, 0
    v_mov_b32 v40, 0
    v_mov_b32 v41, 0
    v_mov_b32 v42, 0
    v_mov_b32 v43, 0
    v_mov_b32 v44, 0
    v_mov_b32 v45, 0
    v_mov_b32 v46, 0
    v_mov_b32 v47, 0
    v_mov_b32 v48, 0
    v_mov_b32 v49, 0
    v_mov_b32 v50, 0
    v_mov_b32 v51, 0
    v_mov_b32 v52, 0
    v_mov_b32 v53, 0
    v_mov_b32 v54, 0
    v_mov_b32 v55, 0
    v_mov_b32 v56, 0
    v_mov_b32 v57, 0
    v_mov_b32 v58, 0
    v_mov_b32 v59, 0
    v_mov_b32 v60, 0
    v_mov_b32 v61, 0
    v_mov_b32 v62, 0
    v_mov_b32 v63, 0
    v_mov_b32 v64, 0
    v_mov_b32 v65, 0
    v_mov_b32 v66, 0
    v_mov_b32 v67, 0
    v_mov_b32 v68, 0
    v_mov_b32 v69, 0
    v_mov_b32 v70, 0
    v_mov_b32 v71, 0
    v_mov_b32 v72, 0
    v_mov_b32 v73, 0
    v_mov_b32 v74, 0
    v_mov_b32 v75, 0
    v_mov_b32 v76, 0
    v_mov_b32 v77, 0
    v_mov_b32 v78, 0
    v_mov_b32 v79, 0
    s_waitcnt lgkmcnt(0)
    s_mov_b32 s8, s42
    s_and_b32 s9, s43, 0xffff
    s_mov_b32 s10, 9437184
    s_mov_b32 s11, 0x20000
    s_mov_b32 s30, 0
    s_mov_b32 s32, 40960
    s_mov_b32 s33, -122880
    s_mov_b32 s34, 9
    s_barrier
    ds_read_b128 v[80:83], v128 offset:0
    ds_read_b128 v[88:91], v129 offset:0
    ds_read_b128 v[92:95], v129 offset:4096
    ds_read_b128 v[96:99], v129 offset:8192
    ds_read_b128 v[100:103], v129 offset:12288
    ds_read_b128 v[104:107], v129 offset:16384
L_k3_bloop:
    s_waitcnt lgkmcnt(4)
    v_mfma_f32_32x32x16_bf16 v[0:15], v[88:91], v[80:83], v[0:15]
    ds_read_b128 v[84:87], v128 offset:4096
    ds_read_b128 v[108:111], v129 offset:1024
    ds_read_b128 v[112:115], v129 offset:5120
    s_waitcnt lgkmcnt(6)
    v_mfma_f32_32x32x16_bf16 v[16:31], v[92:95], v[80:83], v[16:31]
    ds_read_b128 v[116:119], v129 offset:9216
    ds_read_b128 v[120:123], v129 offset:13312
    ds_read_b128 v[124:127], v129 offset:17408
    s_waitcnt lgkmcnt(8)
    v_mfma_f32_32x32x16_bf16 v[32:47], v[96:99], v[80:83], v[32:47]
    s_waitcnt lgkmcnt(7)
    v_mfma_f32_32x32x16_bf16 v[48:63], v[100:103], v[80:83], v[48:63]
    s_waitcnt lgkmcnt(6)
    v_mfma_f32_32x32x16_bf16 v[64:79], v[104:107], v[80:83], v[64:79]
    s_waitcnt lgkmcnt(4)
    v_mfma_f32_32x32x16_bf16 v[0:15], v[108:111], v[84:87], v[0:15]
    ds_read_b128 v[80:83], v128 offset:8192
    ds_read_b128 v[88:91], v129 offset:2048
    ds_read_b128 v[92:95], v129 offset:6144
    s_waitcnt lgkmcnt(6)
    v_mfma_f32_32x32x16_bf16 v[16:31], v[112:115], v[84:87], v[16:31]
    ds_read_b128 v[96:99], v129 offset:10240
    ds_read_b128 v[100:103], v129 offset:14336
    ds_read_b128 v[104:107], v129 offset:18432
    s_waitcnt lgkmcnt(8)
    v_mfma_f32_32x32x16_bf16 v[32:47], v[116:119], v[84:87], v[32:47]
    s_waitcnt lgkmcnt(7)
    v_mfma_f32_32x32x16_bf16 v[48:63], v[120:123], v[84:87], v[48:63]
    s_waitcnt lgkmcnt(6)
    v_mfma_f32_32x32x16_bf16 v[64:79], v[124:127], v[84:87], v[64:79]
    s_cmp_eq_u32 s34, 1
    s_cbranch_scc1 L_k3_bnb
    s_barrier
L_k3_bnb:
    s_waitcnt lgkmcnt(4)
    v_mfma_f32_32x32x16_bf16 v[0:15], v[88:91], v[80:83], v[0:15]
    ds_read_b128 v[84:87], v128 offset:12288
    ds_read_b128 v[108:111], v129 offset:3072
    ds_read_b128 v[112:115], v129 offset:7168
    s_waitcnt lgkmcnt(6)
    v_mfma_f32_32x32x16_bf16 v[16:31], v[92:95], v[80:83], v[16:31]
    ds_read_b128 v[116:119], v129 offset:11264
    ds_read_b128 v[120:123], v129 offset:15360
    ds_read_b128 v[124:127], v129 offset:19456
    s_waitcnt lgkmcnt(8)
    v_mfma_f32_32x32x16_bf16 v[32:47], v[96:99], v[80:83], v[32:47]
    s_waitcnt lgkmcnt(7)
    v_mfma_f32_32x32x16_bf16 v[48:63], v[100:103], v[80:83], v[48:63]
    s_waitcnt lgkmcnt(6)
    v_mfma_f32_32x32x16_bf16 v[64:79], v[104:107], v[80:83], v[64:79]
    s_waitcnt lgkmcnt(4)
    v_mfma_f32_32x32x16_bf16 v[0:15], v[108:111], v[84:87], v[0:15]
    s_add_u32 s30, s30, 1
    s_cmp_eq_u32 s30, 4
    s_cselect_b32 s31, s33, s32
    s_cselect_b32 s30, 0, s30
    v_add_u32 v128, s31, v128
    v_add_u32 v129, s31, v129
    ds_read_b128 v[80:83], v128 offset:0
    ds_read_b128 v[88:91], v129 offset:0
    ds_read_b128 v[92:95], v129 offset:4096
    s_waitcnt lgkmcnt(6)
    v_mfma_f32_32x32x16_bf16 v[16:31], v[112:115], v[84:87], v[16:31]
    ds_read_b128 v[96:99], v129 offset:8192
    ds_read_b128 v[100:103], v129 offset:12288
    ds_read_b128 v[104:107], v129 offset:16384
    s_waitcnt lgkmcnt(8)
    v_mfma_f32_32x32x16_bf16 v[32:47], v[116:119], v[84:87], v[32:47]
    s_waitcnt lgkmcnt(7)
    v_mfma_f32_32x32x16_bf16 v[48:63], v[120:123], v[84:87], v[48:63]
    s_waitcnt lgkmcnt(6)
    v_mfma_f32_32x32x16_bf16 v[64:79], v[124:127], v[84:87], v[64:79]
    s_sub_u32 s34, s34, 1
    s_cmp_lg_u32 s34, 0
    s_cbranch_scc1 L_k3_bloop
    s_waitcnt lgkmcnt(0)
    s_nop 7
    s_nop 3
    ds_write_b128 v133, v[0:3] offset:0
    ds_write_b128 v134, v[4:7] offset:0
    ds_write_b128 v135, v[8:11] offset:0
    ds_write_b128 v136, v[12:15] offset:0
    ds_write_b128 v133, v[16:19] offset:4096
    ds_write_b128 v134, v[20:23] offset:4096
    ds_write_b128 v135, v[24:27] offset:4096
    ds_write_b128 v136, v[28:31] offset:4096
    ds_write_b128 v133, v[32:35] offset:8192
    ds_write_b128 v134, v[36:39] offset:8192
    ds_write_b128 v135, v[40:43] offset:8192
    ds_write_b128 v136, v[44:47] offset:8192
    ds_write_b128 v133, v[48:51] offset:12288
    ds_write_b128 v134, v[52:55] offset:12288
    ds_write_b128 v135, v[56:59] offset:12288
    ds_write_b128 v136, v[60:63] offset:12288
    ds_write_b128 v133, v[64:67] offset:16384
    ds_write_b128 v134, v[68:71] offset:16384
    ds_write_b128 v135, v[72:75] offset:16384
    ds_write_b128 v136, v[76:79] offset:16384
    s_waitcnt lgkmcnt(0)
    ds_read_b128 v[0:3], v131 offset:0
    ds_read_b128 v[4:7], v131 offset:1024
    ds_read_b128 v[8:11], v131 offset:2048
    ds_read_b128 v[12:15], v131 offset:3072
    s_waitcnt lgkmcnt(3)
    s_add_u32 s39, s38, 0
    buffer_store_dwordx4 v[0:3], v132, s[8:11], s39 offen nt
    s_waitcnt lgkmcnt(2)
    s_add_u32 s39, s38, 36864
    buffer_store_dwordx4 v[4:7], v132, s[8:11], s39 offen nt
    s_waitcnt lgkmcnt(1)
    s_add_u32 s39, s38, 73728
    buffer_store_dwordx4 v[8:11], v132, s[8:11], s39 offen nt
    s_waitcnt lgkmcnt(0)
    s_add_u32 s39, s38, 110592
    buffer_store_dwordx4 v[12:15], v132, s[8:11], s39 offen nt
    ds_read_b128 v[16:19], v131 offset:4096
    ds_read_b128 v[20:23], v131 offset:5120
    ds_read_b128 v[24:27], v131 offset:6144
    ds_read_b128 v[28:31], v131 offset:7168
    s_waitcnt lgkmcnt(3)
    s_add_u32 s39, s38, 128
    buffer_store_dwordx4 v[16:19], v132, s[8:11], s39 offen nt
    s_waitcnt lgkmcnt(2)
    s_add_u32 s39, s38, 36992
    buffer_store_dwordx4 v[20:23], v132, s[8:11], s39 offen nt
    s_waitcnt lgkmcnt(1)
    s_add_u32 s39, s38, 73856
    buffer_store_dwordx4 v[24:27], v132, s[8:11], s39 offen nt
    s_waitcnt lgkmcnt(0)
    s_add_u32 s39, s38, 110720
    buffer_store_dwordx4 v[28:31], v132, s[8:11], s39 offen nt
    ds_read_b128 v[32:35], v131 offset:8192
    ds_read_b128 v[36:39], v131 offset:9216
    ds_read_b128 v[40:43], v131 offset:10240
    ds_read_b128 v[44:47], v131 offset:11264
    s_waitcnt lgkmcnt(3)
    s_add_u32 s39, s38, 256
    buffer_store_dwordx4 v[32:35], v132, s[8:11], s39 offen nt
    s_waitcnt lgkmcnt(2)
    s_add_u32 s39, s38, 37120
    buffer_store_dwordx4 v[36:39], v132, s[8:11], s39 offen nt
    s_waitcnt lgkmcnt(1)
    s_add_u32 s39, s38, 73984
    buffer_store_dwordx4 v[40:43], v132, s[8:11], s39 offen nt
    s_waitcnt lgkmcnt(0)
    s_add_u32 s39, s38, 110848
    buffer_store_dwordx4 v[44:47], v132, s[8:11], s39 offen nt
    s_cmp_eq_u32 s6, 3
    s_cbranch_scc1 L_k3_bdone
    ds_read_b128 v[48:51], v131 offset:12288
    ds_read_b128 v[52:55], v131 offset:13312
    ds_read_b128 v[56:59], v131 offset:14336
    ds_read_b128 v[60:63], v131 offset:15360
    s_waitcnt lgkmcnt(3)
    s_add_u32 s39, s38, 384
    buffer_store_dwordx4 v[48:51], v132, s[8:11], s39 offen nt
    s_waitcnt lgkmcnt(2)
    s_add_u32 s39, s38, 37248
    buffer_store_dwordx4 v[52:55], v132, s[8:11], s39 offen nt
    s_waitcnt lgkmcnt(1)
    s_add_u32 s39, s38, 74112
    buffer_store_dwordx4 v[56:59], v132, s[8:11], s39 offen nt
    s_waitcnt lgkmcnt(0)
    s_add_u32 s39, s38, 110976
    buffer_store_dwordx4 v[60:63], v132, s[8:11], s39 offen nt
    ds_read_b128 v[64:67], v131 offset:16384
    ds_read_b128 v[68:71], v131 offset:17408
    ds_read_b128 v[72:75], v131 offset:18432
    ds_read_b128 v[76:79], v131 offset:19456
    s_waitcnt lgkmcnt(3)
    s_add_u32 s39, s38, 512
    buffer_store_dwordx4 v[64:67], v132, s[8:11], s39 offen nt
    s_waitcnt lgkmcnt(2)
    s_add_u32 s39, s38, 37376
    buffer_store_dwordx4 v[68:71], v132, s[8:11], s39 offen nt
    s_waitcnt lgkmcnt(1)
    s_add_u32 s39, s38, 74240
    buffer_store_dwordx4 v[72:75], v132, s[8:11], s39 offen nt
    s_waitcnt lgkmcnt(0)
    s_add_u32 s39, s38, 111104
    buffer_store_dwordx4 v[76:79], v132, s[8:11], s39 offen nt
L_k3_bdone:
    s_endpgm
L_k3_ycons:
    s_and_b32 s36, s3, 1
    s_lshr_b32 s37, s3, 1
    v_and_b32 v3, 31, v2
    v_lshrrev_b32 v4, 5, v2
    s_mul_i32 s38, s6, 96
    s_lshl_b32 s39, s37, 5
    s_add_u32 s38, s38, s39
    v_add_u32 v5, s38, v3
    s_lshl_b32 s39, s5, 6
    s_lshl_b32 s50, s36, 5
    s_add_u32 s39, s39, s50
    v_lshlrev_b32 v6, 2, v4
    v_add_u32 v6, s39, v6
    v_mul_u32_u24 v7, 1152, v6
    v_lshl_add_u32 v114, v5, 1, v7
    v_lshlrev_b32 v115, 1, v5
    v_mul_u32_u24 v113, 4608, v6
    v_lshl_add_u32 v113, v5, 2, v113
    v_lshrrev_b32 v10, 4, v2
    v_bfe_u32 v12, v2, 2, 2
    v_and_b32 v13, 3, v2
    v_lshrrev_b32 v11, 1, v10
    v_and_b32 v10, 1, v10
    v_lshl_add_u32 v11, v11, 3, v12
    v_lshlrev_b32 v11, 6, v11
    v_lshl_add_u32 v11, v10, 5, v11
    v_lshl_add_u32 v11, v13, 3, v11
    s_lshl_b32 s50, s36, 13
    v_add_u32 v90, s50, v11
    s_lshl_b32 s50, s37, 13
    s_add_u32 s50, s50, 16384
    v_add_u32 v91, s50, v8
    s_waitcnt lgkmcnt(0)
    s_mov_b32 s8, s42
    s_and_b32 s9, s43, 0xffff
    s_mov_b32 s10, 9437184
    s_mov_b32 s11, 0x20000
    s_mov_b32 s12, s46
    s_and_b32 s13, s47, 0xffff
    s_mov_b32 s14, 2359296
    s_mov_b32 s15, 0x20000
    s_mov_b32 s16, s48
    s_and_b32 s17, s49, 0xffff
    s_mov_b32 s18, 1152
    s_mov_b32 s19, 0x20000
    v_mov_b32 v0, 0
    v_mov_b32 v1, 0
    v_mov_b32 v2, 0
    v_mov_b32 v3, 0
    v_mov_b32 v4, 0
    v_mov_b32 v5, 0
    v_mov_b32 v6, 0
    v_mov_b32 v7, 0
    v_mov_b32 v8, 0
    v_mov_b32 v9, 0
    v_mov_b32 v10, 0
    v_mov_b32 v11, 0
    v_mov_b32 v12, 0
    v_mov_b32 v13, 0
    v_mov_b32 v14, 0
    v_mov_b32 v15, 0
    s_mov_b32 s30, 0
    s_mov_b32 s32, 40960
    s_mov_b32 s33, -122880
    s_mov_b32 s34, 9
    s_barrier
    ds_read_b64_tr_b16 v[16:17], v90 offset:0
    ds_read_b64_tr_b16 v[18:19], v90 offset:256
    ds_read_b128 v[20:23], v91 offset:0
    ds_read_b64_tr_b16 v[24:25], v90 offset:1024
    ds_read_b64_tr_b16 v[26:27], v90 offset:1280
    ds_read_b128 v[28:31], v91 offset:1024
    ds_read_b64_tr_b16 v[32:33], v90 offset:2048
    ds_read_b64_tr_b16 v[34:35], v90 offset:2304
    ds_read_b128 v[36:39], v91 offset:2048
    ds_read_b64_tr_b16 v[40:41], v90 offset:3072
    ds_read_b64_tr_b16 v[42:43], v90 offset:3328
    ds_read_b128 v[44:47], v91 offset:3072
L_k3_yloop:
    s_waitcnt lgkmcnt(9)
    v_mfma_f32_32x32x16_bf16 v[0:15], v[16:19], v[20:23], v[0:15]
    ds_read_b64_tr_b16 v[48:49], v90 offset:4096
    ds_read_b64_tr_b16 v[50:51], v90 offset:4352
    ds_read_b128 v[52:55], v91 offset:4096
    s_waitcnt lgkmcnt(9)
    v_mfma_f32_32x32x16_bf16 v[0:15], v[24:27], v[28:31], v[0:15]
    ds_read_b64_tr_b16 v[56:57], v90 offset:5120
    ds_read_b64_tr_b16 v[58:59], v90 offset:5376
    ds_read_b128 v[60:63], v91 offset:5120
    s_waitcnt lgkmcnt(9)
    v_mfma_f32_32x32x16_bf16 v[0:15], v[32:35], v[36:39], v[0:15]
    ds_read_b64_tr_b16 v[64:65], v90 offset:6144
    ds_read_b64_tr_b16 v[66:67], v90 offset:6400
    ds_read_b128 v[68:71], v91 offset:6144
    s_waitcnt lgkmcnt(9)
    v_mfma_f32_32x32x16_bf16 v[0:15], v[40:43], v[44:47], v[0:15]
    ds_read_b64_tr_b16 v[72:73], v90 offset:7168
    ds_read_b64_tr_b16 v[74:75], v90 offset:7424
    ds_read_b128 v[76:79], v91 offset:7168
    s_sub_u32 s34, s34, 1
    s_cmp_eq_u32 s34, 0
    s_cbranch_scc1 L_k3_ylast
    s_barrier
    s_cmp_eq_u32 s34, 6
    s_cbranch_scc0 L_k3_ynox
    s_mov_b32 s51, 0
    buffer_load_ushort v96, v114, s[12:15], s51 offen
    s_mov_b32 s51, 1152
    buffer_load_ushort v97, v114, s[12:15], s51 offen
    s_mov_b32 s51, 2304
    buffer_load_ushort v98, v114, s[12:15], s51 offen
    s_mov_b32 s51, 3456
    buffer_load_ushort v99, v114, s[12:15], s51 offen
    s_mov_b32 s51, 9216
    buffer_load_ushort v100, v114, s[12:15], s51 offen
    s_mov_b32 s51, 10368
    buffer_load_ushort v101, v114, s[12:15], s51 offen
    s_mov_b32 s51, 11520
    buffer_load_ushort v102, v114, s[12:15], s51 offen
    s_mov_b32 s51, 12672
    buffer_load_ushort v103, v114, s[12:15], s51 offen
    s_mov_b32 s51, 18432
    buffer_load_ushort v104, v114, s[12:15], s51 offen
    s_mov_b32 s51, 19584
    buffer_load_ushort v105, v114, s[12:15], s51 offen
    s_mov_b32 s51, 20736
    buffer_load_ushort v106, v114, s[12:15], s51 offen
    s_mov_b32 s51, 21888
    buffer_load_ushort v107, v114, s[12:15], s51 offen
    s_mov_b32 s51, 27648
    buffer_load_ushort v108, v114, s[12:15], s51 offen
    s_mov_b32 s51, 28800
    buffer_load_ushort v109, v114, s[12:15], s51 offen
    s_mov_b32 s51, 29952
    buffer_load_ushort v110, v114, s[12:15], s51 offen
    s_mov_b32 s51, 31104
    buffer_load_ushort v111, v114, s[12:15], s51 offen
    buffer_load_ushort v112, v115, s[16:19], 0 offen
L_k3_ynox:
    s_add_u32 s30, s30, 1
    s_cmp_eq_u32 s30, 4
    s_cselect_b32 s31, s33, s32
    s_cselect_b32 s30, 0, s30
    v_add_u32 v90, s31, v90
    v_add_u32 v91, s31, v91
    s_waitcnt lgkmcnt(9)
    v_mfma_f32_32x32x16_bf16 v[0:15], v[48:51], v[52:55], v[0:15]
    ds_read_b64_tr_b16 v[16:17], v90 offset:0
    ds_read_b64_tr_b16 v[18:19], v90 offset:256
    ds_read_b128 v[20:23], v91 offset:0
    s_waitcnt lgkmcnt(9)
    v_mfma_f32_32x32x16_bf16 v[0:15], v[56:59], v[60:63], v[0:15]
    ds_read_b64_tr_b16 v[24:25], v90 offset:1024
    ds_read_b64_tr_b16 v[26:27], v90 offset:1280
    ds_read_b128 v[28:31], v91 offset:1024
    s_waitcnt lgkmcnt(9)
    v_mfma_f32_32x32x16_bf16 v[0:15], v[64:67], v[68:71], v[0:15]
    ds_read_b64_tr_b16 v[32:33], v90 offset:2048
    ds_read_b64_tr_b16 v[34:35], v90 offset:2304
    ds_read_b128 v[36:39], v91 offset:2048
    s_waitcnt lgkmcnt(9)
    v_mfma_f32_32x32x16_bf16 v[0:15], v[72:75], v[76:79], v[0:15]
    ds_read_b64_tr_b16 v[40:41], v90 offset:3072
    ds_read_b64_tr_b16 v[42:43], v90 offset:3328
    ds_read_b128 v[44:47], v91 offset:3072
    s_branch L_k3_yloop
L_k3_ylast:
    s_waitcnt lgkmcnt(9)
    v_mfma_f32_32x32x16_bf16 v[0:15], v[48:51], v[52:55], v[0:15]
    s_waitcnt lgkmcnt(6)
    v_mfma_f32_32x32x16_bf16 v[0:15], v[56:59], v[60:63], v[0:15]
    s_waitcnt lgkmcnt(3)
    v_mfma_f32_32x32x16_bf16 v[0:15], v[64:67], v[68:71], v[0:15]
    s_waitcnt lgkmcnt(0)
    v_mfma_f32_32x32x16_bf16 v[0:15], v[72:75], v[76:79], v[0:15]
    s_waitcnt vmcnt(0)
    v_lshlrev_b32 v112, 16, v112
    v_lshlrev_b32 v96, 16, v96
    v_lshlrev_b32 v97, 16, v97
    v_lshlrev_b32 v98, 16, v98
    v_lshlrev_b32 v99, 16, v99
    v_lshlrev_b32 v100, 16, v100
    v_lshlrev_b32 v101, 16, v101
    v_lshlrev_b32 v102, 16, v102
    v_lshlrev_b32 v103, 16, v103
    v_lshlrev_b32 v104, 16, v104
    v_lshlrev_b32 v105, 16, v105
    v_lshlrev_b32 v106, 16, v106
    v_lshlrev_b32 v107, 16, v107
    v_lshlrev_b32 v108, 16, v108
    v_lshlrev_b32 v109, 16, v109
    v_lshlrev_b32 v110, 16, v110
    v_lshlrev_b32 v111, 16, v111
    v_fmac_f32 v0, v96, v112
    s_mov_b32 s51, 0
    buffer_store_dword v0, v113, s[8:11], s51 offen nt
    v_fmac_f32 v1, v97, v112
    s_mov_b32 s51, 4608
    buffer_store_dword v1, v113, s[8:11], s51 offen nt
    v_fmac_f32 v2, v98, v112
    s_mov_b32 s51, 9216
    buffer_store_dword v2, v113, s[8:11], s51 offen nt
    v_fmac_f32 v3, v99, v112
    s_mov_b32 s51, 13824
    buffer_store_dword v3, v113, s[8:11], s51 offen nt
    v_fmac_f32 v4, v100, v112
    s_mov_b32 s51, 36864
    buffer_store_dword v4, v113, s[8:11], s51 offen nt
    v_fmac_f32 v5, v101, v112
    s_mov_b32 s51, 41472
    buffer_store_dword v5, v113, s[8:11], s51 offen nt
    v_fmac_f32 v6, v102, v112
    s_mov_b32 s51, 46080
    buffer_store_dword v6, v113, s[8:11], s51 offen nt
    v_fmac_f32 v7, v103, v112
    s_mov_b32 s51, 50688
    buffer_store_dword v7, v113, s[8:11], s51 offen nt
    v_fmac_f32 v8, v104, v112
    s_mov_b32 s51, 73728
    buffer_store_dword v8, v113, s[8:11], s51 offen nt
    v_fmac_f32 v9, v105, v112
    s_mov_b32 s51, 78336
    buffer_store_dword v9, v113, s[8:11], s51 offen nt
    v_fmac_f32 v10, v106, v112
    s_mov_b32 s51, 82944
    buffer_store_dword v10, v113, s[8:11], s51 offen nt
    v_fmac_f32 v11, v107, v112
    s_mov_b32 s51, 87552
    buffer_store_dword v11, v113, s[8:11], s51 offen nt
    v_fmac_f32 v12, v108, v112
    s_mov_b32 s51, 110592
    buffer_store_dword v12, v113, s[8:11], s51 offen nt
    v_fmac_f32 v13, v109, v112
    s_mov_b32 s51, 115200
    buffer_store_dword v13, v113, s[8:11], s51 offen nt
    v_fmac_f32 v14, v110, v112
    s_mov_b32 s51, 119808
    buffer_store_dword v14, v113, s[8:11], s51 offen nt
    v_fmac_f32 v15, v111, v112
    s_mov_b32 s51, 124416
    buffer_store_dword v15, v113, s[8:11], s51 offen nt
    s_endpgm
L_k3_end:
    s_endpgm
L_k3_codeend:
.section .rodata,"a"
.p2align 6
.amdhsa_kernel s5mha_k3_kernel
  .amdhsa_next_free_vgpr 144
  .amdhsa_next_free_sgpr 96
  .amdhsa_accum_offset 144
  .amdhsa_group_segment_fixed_size 0
  .amdhsa_kernarg_size 120
  .amdhsa_user_sgpr_count 2
  .amdhsa_user_sgpr_kernarg_segment_ptr 1
  .amdhsa_system_sgpr_workgroup_id_x 1
  .amdhsa_float_denorm_mode_32 3
.end_amdhsa_kernel
```
